```python
import torch

def _softmax(x, axis=-1):
    return torch.softmax(x, dim=axis)
def _gelu(x):
    return torch.nn.functional.gelu(x, approximate="tanh")
def _silu(x):
    return torch.nn.functional.silu(x)
def _sigmoid(x):
    return torch.sigmoid(x)
def _layernorm(x, axis=-1, eps=1e-5):
    m = x.mean(dim=axis, keepdim=True)
    v = x.var(dim=axis, keepdim=True, unbiased=False)
    return (x - m) / torch.sqrt(v + eps)
def _scatter_add(tgt, idx, src, axis=0):
    return tgt.clone().index_add_(axis, idx, src)
def _segment_sum(src, seg, n):
    out = torch.zeros((n,) + src.shape[1:], dtype=src.dtype)
    return out.index_add_(0, seg, src)
def _pad(x, pw):
    flat = tuple(v for pair in reversed(pw) for v in pair)
    return torch.nn.functional.pad(x, flat)

kernel_name = 'sequential_preLN__linear_kernel_hedgehog__dense_activation_gelu__prompt'

def setup_inputs():

    _w = (lambda a: (lambda t: t.to(torch.bfloat16) if t.is_floating_point() else t)(torch.as_tensor(a)))
    def _A_setup():
        B, S, D, H = 1, 2048, 448, 16
        Dh = D // H
        return {
            "x": _w((lambda *s: torch.randn(*s, dtype=torch.bfloat16) * 0.05)(B, S, D)),
            "wqkv": _w((lambda *s: torch.randn(*s, dtype=torch.bfloat16) * 0.2)(D, 3 * D)),
            "w_phi": _w((lambda *s: torch.randn(*s, dtype=torch.bfloat16) * 0.2)(H, Dh, Dh) * (Dh ** -0.5)),
            "wo": _w((lambda *s: torch.randn(*s, dtype=torch.bfloat16) * 0.05)(D, D)),
        }
    _A_in = _A_setup()

    def _B_setup():
        B, S, D, F = 1, 2048, 448, 1792
        return {
            "x": _w((lambda *s: torch.randn(*s, dtype=torch.bfloat16) * 0.05)(B, S, D)),
            "w1": _w((lambda *s: torch.randn(*s, dtype=torch.bfloat16) * 1.6)(D, F) * (D ** -0.5)),
            "b1": _w((lambda *s: torch.randn(*s, dtype=torch.bfloat16) * 0.1)(F) * 0.01),
            "w2": _w((lambda *s: torch.randn(*s, dtype=torch.bfloat16) * 0.1)(F, D) * (F ** -0.5)),
            "b2": _w((lambda *s: torch.randn(*s, dtype=torch.bfloat16) * 0.1)(D) * 0.01),
        }
    _B_in = _B_setup()

    return {
        "A_x": _A_in["x"],
        "A_wqkv": _A_in["wqkv"],
        "A_w_phi": _A_in["w_phi"],
        "A_wo": _A_in["wo"],
        "B_x": _B_in["x"],
        "B_w1": _B_in["w1"],
        "B_b1": _B_in["b1"],
        "B_w2": _B_in["w2"],
        "B_b2": _B_in["b2"],
    }

def reference(A_x, A_wqkv, A_w_phi, A_wo, B_x, B_w1, B_b1, B_w2, B_b2):
    def _A_ref(x, wqkv, w_phi, wo):
        B, S, D = x.shape
        H = 16; Dh = D // H
        qkv = (lambda x, *d: x.permute(*d))((x @ wqkv).reshape(B, S, 3, H, Dh), 2, 0, 3, 1, 4)
        q, k, v = qkv[0], qkv[1], qkv[2]
        pq = torch.einsum("bhsd,hdf->bhsf", q, w_phi)
        pk = torch.einsum("bhsd,hdf->bhsf", k, w_phi)
        phi_q = torch.concatenate([_softmax(pq, axis=-1), _softmax(-pq, axis=-1)], axis=-1)
        phi_k = torch.concatenate([_softmax(pk, axis=-1), _softmax(-pk, axis=-1)], axis=-1)
        kv = torch.einsum("bhsf,bhsd->bhfd", phi_k, v)
        z  = torch.einsum("bhsf->bhf", phi_k)
        num = torch.einsum("bhqf,bhfd->bhqd", phi_q, kv)
        den = torch.einsum("bhqf,bhf->bhq", phi_q, z)[..., None] + 1e-6
        o = num / den
        return (lambda x, *d: x.permute(*d))(o, 0, 2, 1, 3).reshape(B, S, D) @ wo

    def _B_ref(x, w1, b1, w2, b2):
        h = torch.einsum("bsd,df->bsf", x, w1) + b1
        h = _gelu(h)
        return torch.einsum("bsf,fd->bsd", h, w2) + b2

    x = A_x
    h = x + _A_ref(_layernorm(x, axis=-1), A_wqkv, A_w_phi, A_wo)
    h2 = h + _B_ref(_layernorm(h, axis=-1), B_w1, B_b1, B_w2, B_b2)
    return h2
```

```asm
; @launch grid=(256,1,1) block=(256,1,1) lds=163840
.amdgcn_target "amdgcn-amd-amdhsa--gfx950"
.text
.globl sequential_preLN__linear_kernel_hedgehog__dense_activation_gelu__prompt_kernel
.p2align 8
.type sequential_preLN__linear_kernel_hedgehog__dense_activation_gelu__prompt_kernel,@function
sequential_preLN__linear_kernel_hedgehog__dense_activation_gelu__prompt_kernel:
    s_cmp_ge_u32 s2, 256
    s_cbranch_scc1 L_end
    s_load_dwordx16 s[56:71], s[0:1], 0
    s_load_dwordx8 s[72:79], s[0:1], 64
    s_getpc_b64 s[94:95]
L_pc:
    s_lshr_b32 s93, s2, 3
    s_lshl_b32 s93, s93, 2
    v_lshrrev_b32 v10, 6, v0
    v_add_u32 v10, s93, v10
    v_mul_u32_u24 v10, 3, v10
    v_and_b32 v11, 63, v0
    v_add_u32 v10, v10, v11
    v_min_u32 v10, (L_end - L_pc) >> 7, v10
    v_lshlrev_b32 v10, 7, v10
    v_mov_b32 v13, s95
    v_add_co_u32 v12, vcc, s94, v10
    s_nop 1
    v_addc_co_u32 v13, vcc, 0, v13, vcc
    v_cmp_gt_u32 vcc, 3, v11
    s_nop 0
    s_and_saveexec_b64 s[92:93], vcc
    global_load_dword a252, v[12:13], off
    s_mov_b64 exec, s[92:93]
    s_getreg_b32 s51, hwreg(HW_REG_XCC_ID, 0, 4)
    s_and_b32 s44, s2, 7
    s_lshr_b32 s45, s2, 3
    s_and_b32 s46, s45, 15
    s_lshr_b32 s53, s45, 4
    s_lshl_b32 s52, s44, 1
    s_add_u32 s52, s52, s53
    s_lshl_b32 s48, s52, 7
    v_lshrrev_b32 v7, 6, v0
    v_and_b32 v1, 63, v0
    v_readfirstlane_b32 s47, v7
    v_and_b32 v2, 31, v1
    v_lshrrev_b32 v3, 5, v1
    v_lshrrev_b32 v52, 3, v1
    v_mul_u32_u24 v52, 896, v52
    v_and_b32 v53, 7, v1
    v_lshrrev_b32 v54, 4, v1
    v_xor_b32 v55, v53, v54
    v_lshl_add_u32 v4, v55, 4, v52
    v_xor_b32 v55, 4, v55
    v_lshl_add_u32 v5, v55, 4, v52
    v_lshrrev_b32 v52, 2, v1
    v_mul_u32_u24 v52, 2688, v52
    v_and_b32 v53, 3, v1
    v_lshl_add_u32 v6, v53, 4, v52
    v_lshlrev_b32 v62, 4, v1
    s_lshl_b32 s53, s47, 4
    s_mul_i32 s92, s53, 2688
    s_mul_i32 s54, s46, 56
    s_and_b32 s54, s54, 0xfffffff0
    s_add_u32 s92, s92, s54
    s_lshl_b32 s93, s47, 5
    s_add_u32 s93, s93, s48
    s_mul_i32 s93, s93, 896
    s_waitcnt lgkmcnt(0)
    s_mov_b32 s8, s58
    s_mov_b32 s9, s59
    s_mov_b32 s10, 1204224
    s_mov_b32 s11, 0x20000
    s_mov_b32 s4, s56
    s_mov_b32 s5, s57
    s_mov_b32 s6, 1835008
    s_mov_b32 s7, 0x20000
    s_mov_b32 s82, s60
    s_mov_b32 s83, s61
    s_mov_b32 s84, s62
    s_mov_b32 s85, s63
    s_mov_b32 s60, s92
    s_mov_b32 s61, s93
    s_lshl_b32 s62, s47, 10
    s_add_u32 s62, s62, 24576
    s_lshl_b32 s63, s47, 12
    s_add_u32 s63, s63, 8192
    s_add_u32 m0, s62, 0
    s_add_u32 s59, s60, 896
    buffer_load_dwordx4 v6, s[8:11], s59 offen lds
    s_add_u32 m0, s62, 4096
    s_add_u32 s59, s60, 1792
    buffer_load_dwordx4 v6, s[8:11], s59 offen lds
    s_add_u32 m0, s63, 0
    s_add_u32 s59, s61, 0
    buffer_load_dwordx4 v4, s[4:7], s59 offen lds
    s_add_u32 m0, s63, 1024
    s_add_u32 s59, s61, 7168
    buffer_load_dwordx4 v5, s[4:7], s59 offen lds
    s_add_u32 m0, s63, 2048
    s_add_u32 s59, s61, 14336
    buffer_load_dwordx4 v4, s[4:7], s59 offen lds
    s_add_u32 m0, s63, 3072
    s_add_u32 s59, s61, 21504
    buffer_load_dwordx4 v5, s[4:7], s59 offen lds
    s_add_u32 m0, s62, 24576
    s_add_u32 s59, s60, 172928
    buffer_load_dwordx4 v6, s[8:11], s59 offen lds
    s_add_u32 m0, s62, 28672
    s_add_u32 s59, s60, 173824
    buffer_load_dwordx4 v6, s[8:11], s59 offen lds
    s_add_u32 m0, s63, 24576
    s_add_u32 s59, s61, 128
    buffer_load_dwordx4 v4, s[4:7], s59 offen lds
    s_add_u32 m0, s63, 25600
    s_add_u32 s59, s61, 7296
    buffer_load_dwordx4 v5, s[4:7], s59 offen lds
    s_add_u32 m0, s63, 26624
    s_add_u32 s59, s61, 14464
    buffer_load_dwordx4 v4, s[4:7], s59 offen lds
    s_add_u32 m0, s63, 27648
    s_add_u32 s59, s61, 21632
    buffer_load_dwordx4 v5, s[4:7], s59 offen lds
    s_lshl_b32 s53, s45, 8
    v_add_u32 v52, s53, v0
    v_mul_u32_u24 v53, 9363, v52
    v_lshrrev_b32 v53, 16, v53
    v_mul_u32_u24 v54, 7, v53
    v_sub_u32 v54, v52, v54
    s_lshl_b32 s54, s44, 8
    v_add_u32 v53, s54, v53
    v_mul_u32_u24 v53, 896, v53
    v_lshl_add_u32 v53, v54, 7, v53
    v_mov_b32 v55, 0x80000000
    v_cmp_gt_u32 vcc, 1792, v52
    s_nop 1
    v_cndmask_b32 v53, v55, v53, vcc
    buffer_load_dword a250, v53, s[4:7], 0 offen
    v_subrev_u32 v52, 1792, v52
    v_lshrrev_b32 v53, 1, v52
    v_mul_u32_u24 v53, 9363, v53
    v_lshrrev_b32 v53, 16, v53
    v_mul_u32_u24 v54, 14, v53
    v_sub_u32 v54, v52, v54
    v_mul_u32_u24 v53, 2688, v53
    v_lshl_add_u32 v53, v54, 7, v53
    v_add_u32 v53, 896, v53
    v_cmp_gt_u32 vcc, 6272, v52
    s_nop 1
    v_cndmask_b32 v53, v55, v53, vcc
    buffer_load_dword a251, v53, s[8:11], 0 offen
    s_mov_b32 s40, s78
    s_mov_b32 s41, s79
    s_mov_b32 s42, 33554432
    s_mov_b32 s43, 0x20000
    s_load_dword s49, s[40:41], 0
    s_mul_i32 s53, s46, 1568
    s_add_u32 s12, s82, s53
    s_addc_u32 s13, s83, 0
    s_mov_b32 s14, 1568
    s_mov_b32 s15, 0x20000
    s_mov_b32 s16, s84
    s_mov_b32 s17, s85
    s_mov_b32 s18, 401408
    s_mov_b32 s19, 0x20000
    s_mov_b32 s20, s66
    s_mov_b32 s21, s67
    s_mov_b32 s22, 1605632
    s_mov_b32 s23, 0x20000
    s_mov_b32 s24, s68
    s_mov_b32 s25, s69
    s_mov_b32 s26, 3584
    s_mov_b32 s27, 0x20000
    s_mov_b32 s28, s70
    s_mov_b32 s29, s71
    s_mov_b32 s30, 1605632
    s_mov_b32 s31, 0x20000
    s_mov_b32 s32, s72
    s_mov_b32 s33, s73
    s_mov_b32 s34, 896
    s_mov_b32 s35, 0x20000
    s_mov_b32 s36, s74
    s_mov_b32 s37, s75
    s_mov_b32 s38, 1835008
    s_mov_b32 s39, 0x20000
    s_mul_i32 s53, s47, 448
    s_add_u32 m0, s53, 0
    s_mov_b64 exec, 0xfffffff
    buffer_load_dwordx4 v62, s[12:15], s53 offen lds
    s_mov_b64 exec, -1
    s_cmp_lt_u32 s45, 28
    s_cselect_b32 s68, 1, 0
    s_mul_i32 s53, s45, 37
    s_lshr_b32 s64, s53, 8
    s_mul_i32 s53, s64, 7
    s_sub_u32 s65, s45, s53
    s_cmp_ge_u32 s45, 14
    s_cselect_b32 s66, 1, 0
    s_mul_i32 s53, s66, 14
    s_sub_u32 s67, s45, s53
    s_add_u32 m0, s62, 49152
    s_add_u32 s59, s60, 344960
    buffer_load_dwordx4 v6, s[8:11], s59 offen lds
    s_mov_b32 s72, 0
    s_mov_b32 s73, -1
    s_mov_b32 s74, 0xf0000000
    s_mov_b32 s75, 0xf0000000
    s_mov_b32 s76, 0x22222222
    s_mov_b32 s77, 0x22222222
    s_mov_b32 s78, 0x44444444
    s_mov_b32 s79, 0x44444444
    s_mov_b32 s80, 0x88888888
    s_mov_b32 s81, 0x88888888
    s_cmp_ge_u32 s47, 2
    s_cselect_b32 s70, -1, 0
    s_mov_b32 s71, s70
    s_add_u32 m0, s62, 53248
    s_add_u32 s59, s60, 345856
    buffer_load_dwordx4 v6, s[8:11], s59 offen lds
    s_mul_i32 s83, s47, 301056
    s_mul_i32 s54, s46, 56
    s_and_b32 s54, s54, 0xfffffff0
    s_add_u32 s83, s83, s54
    s_mul_i32 s82, s47, 7168
    s_add_u32 s82, s82, 131072
    v_lshrrev_b32 v52, 1, v2
    v_and_b32 v52, 7, v52
    v_lshlrev_b32 v53, 7, v2
    v_add_u32 v53, s63, v53
    s_add_u32 m0, s63, 49152
    s_add_u32 s59, s61, 256
    buffer_load_dwordx4 v4, s[4:7], s59 offen lds
    s_add_u32 s53, s47, 0
    s_and_b32 s53, s53, 3
    s_lshl_b32 s54, s53, 1
    v_add_u32 v54, s54, v3
    v_xor_b32 v54, v54, v52
    v_lshl_add_u32 v8, v54, 4, v53
    s_add_u32 s53, s47, 1
    s_and_b32 s53, s53, 3
    s_lshl_b32 s54, s53, 1
    v_add_u32 v54, s54, v3
    s_add_u32 m0, s63, 50176
    s_add_u32 s59, s61, 7424
    buffer_load_dwordx4 v5, s[4:7], s59 offen lds
    v_xor_b32 v54, v54, v52
    v_lshl_add_u32 v9, v54, 4, v53
    s_add_u32 s53, s47, 2
    s_and_b32 s53, s53, 3
    s_lshl_b32 s54, s53, 1
    v_add_u32 v54, s54, v3
    v_xor_b32 v54, v54, v52
    v_lshl_add_u32 v10, v54, 4, v53
    s_add_u32 s53, s47, 3
    s_and_b32 s53, s53, 3
    s_lshl_b32 s54, s53, 1
    v_add_u32 v54, s54, v3
    s_add_u32 m0, s63, 51200
    s_add_u32 s59, s61, 14592
    buffer_load_dwordx4 v4, s[4:7], s59 offen lds
    v_xor_b32 v54, v54, v52
    v_lshl_add_u32 v11, v54, 4, v53
    v_and_b32 v52, 15, v1
    v_lshrrev_b32 v58, 2, v52
    v_lshl_add_u32 v52, v3, 3, v58
    v_lshlrev_b32 v52, 6, v52
    v_bfe_u32 v59, v1, 4, 1
    v_lshl_add_u32 v52, v59, 5, v52
    v_and_b32 v60, 3, v1
    v_lshl_add_u32 v52, v60, 3, v52
    s_add_u32 m0, s63, 52224
    s_add_u32 s59, s61, 21760
    buffer_load_dwordx4 v5, s[4:7], s59 offen lds
    s_and_b32 s53, s46, 1
    s_lshl_b32 s53, s53, 3
    s_add_u32 s55, s53, 24576
    s_add_u32 s53, s47, 0
    s_and_b32 s53, s53, 3
    s_lshl_b32 s53, s53, 10
    s_add_u32 s53, s53, s55
    v_add_u32 v12, s53, v52
    s_add_u32 s53, s47, 1
    s_and_b32 s53, s53, 3
    s_lshl_b32 s53, s53, 10
    s_add_u32 s53, s53, s55
    v_add_u32 v13, s53, v52
    s_add_u32 s53, s47, 2
    s_and_b32 s53, s53, 3
    s_lshl_b32 s53, s53, 10
    s_add_u32 s53, s53, s55
    v_add_u32 v14, s53, v52
    s_add_u32 s53, s47, 3
    s_and_b32 s53, s53, 3
    s_lshl_b32 s53, s53, 10
    s_add_u32 s53, s53, s55
    v_add_u32 v15, s53, v52
    v_mov_b32 v56, 0x3f80
    v_mov_b32 v57, 0x3f800000
    v_lshlrev_b32 v53, 2, v3
    v_sub_u32 v52, v2, v53
    v_cmp_eq_u32 vcc, 0, v52
    s_nop 1
    v_cndmask_b32 v54, 0, v56, vcc
    v_cmp_eq_u32 vcc, 1, v52
    s_nop 1
    v_cndmask_b32 v54, v54, v57, vcc
    v_accvgpr_write_b32 a176, v54
    v_cmp_eq_u32 vcc, 2, v52
    s_nop 1
    v_cndmask_b32 v54, 0, v56, vcc
    v_cmp_eq_u32 vcc, 3, v52
    s_nop 1
    v_cndmask_b32 v54, v54, v57, vcc
    v_accvgpr_write_b32 a177, v54
    v_cmp_eq_u32 vcc, 8, v52
    s_nop 1
    v_cndmask_b32 v54, 0, v56, vcc
    v_cmp_eq_u32 vcc, 9, v52
    s_nop 1
    v_cndmask_b32 v54, v54, v57, vcc
    v_accvgpr_write_b32 a178, v54
    v_cmp_eq_u32 vcc, 10, v52
    s_nop 1
    v_cndmask_b32 v54, 0, v56, vcc
    v_cmp_eq_u32 vcc, 11, v52
    s_nop 1
    v_cndmask_b32 v54, v54, v57, vcc
    v_accvgpr_write_b32 a179, v54
    s_and_b32 s53, s47, 1
    s_lshl_b32 s53, s53, 4
    v_xor_b32 v52, s53, v2
    v_sub_u32 v52, v52, v53
    v_cmp_eq_u32 vcc, 0, v52
    s_nop 1
    v_cndmask_b32 v16, 0, v56, vcc
    v_cmp_eq_u32 vcc, 1, v52
    s_nop 1
    v_cndmask_b32 v16, v16, v57, vcc
    v_cmp_eq_u32 vcc, 2, v52
    s_nop 1
    v_cndmask_b32 v17, 0, v56, vcc
    v_cmp_eq_u32 vcc, 3, v52
    s_nop 1
    v_cndmask_b32 v17, v17, v57, vcc
    v_cmp_eq_u32 vcc, 8, v52
    s_nop 1
    v_cndmask_b32 v18, 0, v56, vcc
    v_cmp_eq_u32 vcc, 9, v52
    s_nop 1
    v_cndmask_b32 v18, v18, v57, vcc
    v_cmp_eq_u32 vcc, 10, v52
    s_nop 1
    v_cndmask_b32 v19, 0, v56, vcc
    v_cmp_eq_u32 vcc, 11, v52
    s_nop 1
    v_cndmask_b32 v19, v19, v57, vcc
    v_cmp_eq_u32 vcc, 16, v52
    s_nop 1
    v_cndmask_b32 v20, 0, v56, vcc
    v_cmp_eq_u32 vcc, 17, v52
    s_nop 1
    v_cndmask_b32 v20, v20, v57, vcc
    v_cmp_eq_u32 vcc, 18, v52
    s_nop 1
    v_cndmask_b32 v21, 0, v56, vcc
    v_cmp_eq_u32 vcc, 19, v52
    s_nop 1
    v_cndmask_b32 v21, v21, v57, vcc
    v_cmp_eq_u32 vcc, 24, v52
    s_nop 1
    v_cndmask_b32 v22, 0, v56, vcc
    v_cmp_eq_u32 vcc, 25, v52
    s_nop 1
    v_cndmask_b32 v22, v22, v57, vcc
    v_cmp_eq_u32 vcc, 26, v52
    s_nop 1
    v_cndmask_b32 v23, 0, v56, vcc
    v_cmp_eq_u32 vcc, 27, v52
    s_nop 1
    v_cndmask_b32 v23, v23, v57, vcc
    v_mov_b32 v24, 0x3f803f80
    v_mov_b32 v25, 0x3f803f80
    v_mov_b32 v64, 0
    v_mov_b32 v65, 0
    v_mov_b32 v66, 0
    v_mov_b32 v67, 0
    v_mov_b32 v68, 0
    v_mov_b32 v69, 0
    v_mov_b32 v70, 0
    v_mov_b32 v71, 0
    v_mov_b32 v72, 0
    v_mov_b32 v73, 0
    v_mov_b32 v74, 0
    v_mov_b32 v75, 0
    v_mov_b32 v76, 0
    v_mov_b32 v77, 0
    v_mov_b32 v78, 0
    v_mov_b32 v79, 0
    v_mov_b32 v80, 0
    v_mov_b32 v81, 0
    v_mov_b32 v82, 0
    v_mov_b32 v83, 0
    v_mov_b32 v84, 0
    v_mov_b32 v85, 0
    v_mov_b32 v86, 0
    v_mov_b32 v87, 0
    v_mov_b32 v88, 0
    v_mov_b32 v89, 0
    v_mov_b32 v90, 0
    v_mov_b32 v91, 0
    v_mov_b32 v92, 0
    v_mov_b32 v93, 0
    v_mov_b32 v94, 0
    v_mov_b32 v95, 0
    v_mov_b32 v112, 0
    v_mov_b32 v113, 0
    v_mov_b32 v114, 0
    v_mov_b32 v115, 0
    v_mov_b32 v116, 0
    v_mov_b32 v117, 0
    v_mov_b32 v118, 0
    v_mov_b32 v119, 0
    v_mov_b32 v120, 0
    v_mov_b32 v121, 0
    v_mov_b32 v122, 0
    v_mov_b32 v123, 0
    v_mov_b32 v124, 0
    v_mov_b32 v125, 0
    v_mov_b32 v126, 0
    v_mov_b32 v127, 0
    v_mov_b32 v240, 0
    v_mov_b32 v241, 0
    v_mov_b32 v242, 0
    v_mov_b32 v243, 0
    v_mov_b32 v244, 0
    v_mov_b32 v245, 0
    v_mov_b32 v246, 0
    v_mov_b32 v247, 0
    v_mov_b32 v248, 0
    v_mov_b32 v249, 0
    v_mov_b32 v250, 0
    v_mov_b32 v251, 0
    v_mov_b32 v252, 0
    v_mov_b32 v253, 0
    v_mov_b32 v254, 0
    v_mov_b32 v255, 0
    v_mov_b32 v36, 0
    v_mov_b32 v37, 0
    v_mov_b32 v40, 0
    v_mov_b32 v41, 0
    v_mov_b32 v44, 0
    v_mov_b32 v45, 0
    v_and_b32 v58, 15, v1
    v_lshrrev_b32 v58, 2, v58
    v_bfe_u32 v59, v1, 4, 1
    v_and_b32 v60, 3, v1
    s_mul_i32 s92, s47, 28672
    s_add_u32 s92, s92, 8192
    s_lshl_b32 s53, s46, 4
    s_add_u32 s53, s53, s52
    s_lshl_b32 s53, s53, 2
    s_add_u32 s53, s53, s47
    s_lshl_b32 s53, s53, 10
    s_add_u32 s101, s53, 1048576
    s_lshl_b32 s54, s46, 2
    s_add_u32 s54, s54, s47
    s_lshl_b32 s54, s54, 6
    s_add_u32 s54, s54, 4096
    s_lshl_b32 s53, s52, 2
    s_add_u32 s54, s54, s53
    v_mov_b32 v52, 0x80000000
    v_writelane_b32 v52, s54, 0
    v_accvgpr_write_b32 a139, v52
    v_lshl_add_u32 v52, v3, 2, v58
    v_mul_u32_u24 v56, 56, v52
    v_lshl_add_u32 v56, v59, 5, v56
    v_lshl_add_u32 v56, v60, 3, v56
    v_accvgpr_write_b32 a161, v56
    s_xor_b32 s53, s47, 1
    s_mul_i32 s53, s53, 28672
    s_add_u32 s53, s53, 22528
    v_add_u32 v52, s53, v62
    v_accvgpr_write_b32 a140, v52
    s_xor_b32 s53, s47, 2
    s_mul_i32 s53, s53, 28672
    s_add_u32 s53, s53, 24576
    v_add_u32 v52, s53, v62
    v_accvgpr_write_b32 a141, v52
    s_xor_b32 s53, s47, 3
    s_mul_i32 s53, s53, 28672
    s_add_u32 s53, s53, 26624
    v_add_u32 v52, s53, v62
    v_accvgpr_write_b32 a142, v52
    s_add_u32 s53, s92, 14336
    v_add_u32 v52, s53, v62
    v_accvgpr_write_b32 a143, v52
    s_lshl_b32 s53, s47, 7
    v_lshlrev_b32 v52, 2, v2
    v_add_u32 v52, s53, v52
    v_accvgpr_write_b32 a144, v52
    v_lshlrev_b32 v52, 4, v3
    v_add_u32 v52, s53, v52
    v_accvgpr_write_b32 a145, v52
    s_lshl_b32 s53, s47, 2
    v_add_u32 v52, s53, v62
    v_accvgpr_write_b32 a162, v52
    s_mul_i32 s93, s47, 10240
    s_add_u32 s93, s93, 122880
    s_lshl_b32 s55, s65, 7
    s_mul_i32 s94, s47, 100352
    s_add_u32 s94, s94, s55
    s_mul_i32 s95, s47, 401408
    s_add_u32 s95, s95, s55
    s_mul_i32 s100, s47, 401408
    s_lshl_b32 s55, s67, 8
    s_add_u32 s100, s100, s55
    v_lshrrev_b32 v52, 3, v1
    v_mul_u32_u24 v52, 896, v52
    v_lshlrev_b32 v53, 2, v59
    v_and_b32 v54, 7, v1
    v_xor_b32 v53, v53, v54
    v_lshl_add_u32 v52, v53, 4, v52
    v_accvgpr_write_b32 a128, v52
    v_lshrrev_b32 v52, 4, v1
    v_lshlrev_b32 v53, 2, v52
    v_mul_u32_u24 v52, 3584, v52
    v_and_b32 v54, 15, v1
    v_xor_b32 v53, v53, v54
    v_lshl_add_u32 v52, v53, 4, v52
    v_accvgpr_write_b32 a129, v52
    s_lshl_b32 s53, 1, s46
    s_and_b32 s54, s53, 54699
    s_sub_u32 s53, s53, 1
    s_and_b32 s53, s53, 54699
    s_bcnt1_i32_b32 s53, s53
    s_lshr_b32 s55, s45, 4
    s_mul_i32 s55, s55, 10
    s_add_u32 s53, s53, s55
    s_lshl_b32 s53, s53, 2
    s_add_u32 s53, s53, s47
    s_mul_i32 s55, s53, 157
    v_add_u32 v46, s55, v1
    v_lshlrev_b32 v46, 7, v46
    s_mul_i32 s55, s53, 40
    v_add_u32 v54, s55, v1
    v_lshlrev_b32 v47, 7, v54
    v_mul_u32_u24 v55, 9363, v54
    v_lshrrev_b32 v55, 16, v55
    v_mul_u32_u24 v56, 7, v55
    v_sub_u32 v56, v54, v56
    v_mul_u32_u24 v55, 2688, v55
    v_lshl_add_u32 v48, v56, 7, v55
    s_mul_i32 s55, s53, 20
    s_mul_i32 s56, s44, 1568
    s_add_u32 s55, s55, s56
    v_add_u32 v49, s55, v1
    v_lshlrev_b32 v49, 7, v49
    v_mov_b32 v52, 0x80000000
    v_cmp_gt_u32 vcc, 54, v1
    s_nop 1
    v_cndmask_b32 v46, v52, v46, vcc
    v_cmp_gt_u32 vcc, 40, v1
    s_nop 1
    v_cndmask_b32 v47, v52, v47, vcc
    v_cndmask_b32 v48, v52, v48, vcc
    v_cmp_gt_u32 vcc, 20, v1
    s_nop 1
    v_cndmask_b32 v49, v52, v49, vcc
    s_cmp_lg_u32 s54, 0
    s_cselect_b32 s55, 0, 0x80000000
    v_or_b32 v46, s55, v46
    v_or_b32 v47, s55, v47
    v_or_b32 v48, s55, v48
    v_or_b32 v49, s55, v49
    s_waitcnt lgkmcnt(0)
    s_add_u32 s49, s49, 1
    s_lshl_b32 s53, s44, 8
    s_lshl_b32 s54, s45, 3
    s_add_u32 s53, s53, s54
    s_add_u32 s53, s53, 1024
    v_mov_b32 v52, s53
    v_cmp_eq_u32 vcc, 0, v0
    v_mov_b32 v53, 0x80000000
    s_nop 0
    v_cndmask_b32 v52, v53, v52, vcc
    v_mov_b32 v54, s49
    v_mov_b32 v55, s51
    buffer_store_dwordx2 v[54:55], v52, s[40:43], 0 offen sc1
    s_waitcnt vmcnt(16)
    s_barrier
    ds_read_b128 v[128:131], v8 offset:0
    ds_read_b64_tr_b16 v[96:97], v12 offset:0
    ds_read_b64_tr_b16 v[98:99], v12 offset:256
    ds_read_b64_tr_b16 v[100:101], v12 offset:4096
    ds_read_b64_tr_b16 v[102:103], v12 offset:4352
    s_waitcnt lgkmcnt(0)
    v_mfma_f32_32x32x16_bf16 v[64:79], v[96:99], v[128:131], v[64:79]
    ds_read_b128 v[132:135], v9 offset:0
    ds_read_b64_tr_b16 v[104:105], v13 offset:0
    ds_read_b64_tr_b16 v[106:107], v13 offset:256
    ds_read_b64_tr_b16 v[108:109], v13 offset:4096
    ds_read_b64_tr_b16 v[110:111], v13 offset:4352
    v_mfma_f32_32x32x16_bf16 v[80:95], v[128:131], v[100:103], v[80:95]
    s_add_u32 m0, s62, 73728
    s_add_u32 s59, s60, 516992
    buffer_load_dwordx4 v6, s[8:11], s59 offen lds
    s_add_u32 m0, s62, 77824
    s_add_u32 s59, s60, 517888
    buffer_load_dwordx4 v6, s[8:11], s59 offen lds
    v_mfma_f32_4x4x4_16b_bf16 v[112:115], v[128:129], v[128:129], v[112:115]
    v_mfma_f32_4x4x4_16b_bf16 v[120:123], v[24:25], v[128:129], v[120:123]
    v_mfma_f32_4x4x4_16b_bf16 v[116:119], v[130:131], v[130:131], v[116:119]
    v_mfma_f32_4x4x4_16b_bf16 v[124:127], v[24:25], v[130:131], v[124:127]
    v_mfma_f32_4x4x4_16b_bf16 v[240:243], v[24:25], v[96:97], v[240:243]
    v_mfma_f32_4x4x4_16b_bf16 v[248:251], v[24:25], v[100:101], v[248:251]
    v_mfma_f32_4x4x4_16b_bf16 v[244:247], v[24:25], v[98:99], v[244:247]
    v_mfma_f32_4x4x4_16b_bf16 v[252:255], v[24:25], v[102:103], v[252:255]
    s_waitcnt lgkmcnt(0)
    v_mfma_f32_32x32x16_bf16 v[64:79], v[104:107], v[132:135], v[64:79]
    ds_read_b128 v[136:139], v10 offset:0
    ds_read_b64_tr_b16 v[96:97], v14 offset:0
    ds_read_b64_tr_b16 v[98:99], v14 offset:256
    ds_read_b64_tr_b16 v[100:101], v14 offset:4096
    ds_read_b64_tr_b16 v[102:103], v14 offset:4352
    v_mfma_f32_32x32x16_bf16 v[80:95], v[132:135], v[108:111], v[80:95]
    s_add_u32 m0, s63, 73728
    s_add_u32 s59, s61, 384
    buffer_load_dwordx4 v4, s[4:7], s59 offen lds
    s_add_u32 m0, s63, 74752
    s_add_u32 s59, s61, 7552
    buffer_load_dwordx4 v5, s[4:7], s59 offen lds
    v_mfma_f32_4x4x4_16b_bf16 v[112:115], v[132:133], v[132:133], v[112:115]
    v_mfma_f32_4x4x4_16b_bf16 v[120:123], v[24:25], v[132:133], v[120:123]
    v_mfma_f32_4x4x4_16b_bf16 v[116:119], v[134:135], v[134:135], v[116:119]
    v_mfma_f32_4x4x4_16b_bf16 v[124:127], v[24:25], v[134:135], v[124:127]
    s_waitcnt lgkmcnt(0)
    v_mfma_f32_32x32x16_bf16 v[64:79], v[96:99], v[136:139], v[64:79]
    ds_read_b128 v[140:143], v11 offset:0
    ds_read_b64_tr_b16 v[104:105], v15 offset:0
    ds_read_b64_tr_b16 v[106:107], v15 offset:256
    ds_read_b64_tr_b16 v[108:109], v15 offset:4096
    ds_read_b64_tr_b16 v[110:111], v15 offset:4352
    v_mfma_f32_32x32x16_bf16 v[80:95], v[136:139], v[100:103], v[80:95]
    s_add_u32 m0, s63, 75776
    s_add_u32 s59, s61, 14720
    buffer_load_dwordx4 v4, s[4:7], s59 offen lds
    v_mfma_f32_4x4x4_16b_bf16 v[112:115], v[136:137], v[136:137], v[112:115]
    v_mfma_f32_4x4x4_16b_bf16 v[120:123], v[24:25], v[136:137], v[120:123]
    v_mfma_f32_4x4x4_16b_bf16 v[116:119], v[138:139], v[138:139], v[116:119]
    v_mfma_f32_4x4x4_16b_bf16 v[124:127], v[24:25], v[138:139], v[124:127]
    s_waitcnt lgkmcnt(0)
    v_mfma_f32_32x32x16_bf16 v[64:79], v[104:107], v[140:143], v[64:79]
    s_waitcnt vmcnt(15)
    s_barrier
    ds_read_b128 v[144:147], v8 offset:24576
    ds_read_b64_tr_b16 v[96:97], v12 offset:24576
    ds_read_b64_tr_b16 v[98:99], v12 offset:24832
    ds_read_b64_tr_b16 v[100:101], v12 offset:28672
    ds_read_b64_tr_b16 v[102:103], v12 offset:28928
    v_mfma_f32_32x32x16_bf16 v[80:95], v[140:143], v[108:111], v[80:95]
    s_add_u32 m0, s63, 76800
    s_add_u32 s59, s61, 21888
    buffer_load_dwordx4 v5, s[4:7], s59 offen lds
    v_mfma_f32_4x4x4_16b_bf16 v[112:115], v[140:141], v[140:141], v[112:115]
    v_mfma_f32_4x4x4_16b_bf16 v[120:123], v[24:25], v[140:141], v[120:123]
    v_mfma_f32_4x4x4_16b_bf16 v[116:119], v[142:143], v[142:143], v[116:119]
    v_mfma_f32_4x4x4_16b_bf16 v[124:127], v[24:25], v[142:143], v[124:127]
    s_waitcnt lgkmcnt(0)
    v_mfma_f32_32x32x16_bf16 v[64:79], v[96:99], v[144:147], v[64:79]
    ds_read_b128 v[148:151], v9 offset:24576
    ds_read_b64_tr_b16 v[104:105], v13 offset:24576
    ds_read_b64_tr_b16 v[106:107], v13 offset:24832
    ds_read_b64_tr_b16 v[108:109], v13 offset:28672
    ds_read_b64_tr_b16 v[110:111], v13 offset:28928
    v_mfma_f32_32x32x16_bf16 v[80:95], v[144:147], v[100:103], v[80:95]
    s_add_u32 m0, s62, 98304
    s_add_u32 s59, s60, 689024
    buffer_load_dwordx4 v6, s[8:11], s59 offen lds
    s_add_u32 m0, s62, 102400
    s_add_u32 s59, s60, 689920
    buffer_load_dwordx4 v6, s[8:11], s59 offen lds
    v_mfma_f32_4x4x4_16b_bf16 v[112:115], v[144:145], v[144:145], v[112:115]
    v_mfma_f32_4x4x4_16b_bf16 v[120:123], v[24:25], v[144:145], v[120:123]
    v_mfma_f32_4x4x4_16b_bf16 v[116:119], v[146:147], v[146:147], v[116:119]
    v_mfma_f32_4x4x4_16b_bf16 v[124:127], v[24:25], v[146:147], v[124:127]
    v_mfma_f32_4x4x4_16b_bf16 v[240:243], v[24:25], v[96:97], v[240:243]
    v_mfma_f32_4x4x4_16b_bf16 v[248:251], v[24:25], v[100:101], v[248:251]
    v_mfma_f32_4x4x4_16b_bf16 v[244:247], v[24:25], v[98:99], v[244:247]
    v_mfma_f32_4x4x4_16b_bf16 v[252:255], v[24:25], v[102:103], v[252:255]
    s_waitcnt lgkmcnt(0)
    v_mfma_f32_32x32x16_bf16 v[64:79], v[104:107], v[148:151], v[64:79]
    ds_read_b128 v[152:155], v10 offset:24576
    ds_read_b64_tr_b16 v[96:97], v14 offset:24576
    ds_read_b64_tr_b16 v[98:99], v14 offset:24832
    ds_read_b64_tr_b16 v[100:101], v14 offset:28672
    ds_read_b64_tr_b16 v[102:103], v14 offset:28928
    v_mfma_f32_32x32x16_bf16 v[80:95], v[148:151], v[108:111], v[80:95]
    s_add_u32 m0, s63, 98304
    s_add_u32 s59, s61, 512
    buffer_load_dwordx4 v4, s[4:7], s59 offen lds
    s_add_u32 m0, s63, 99328
    s_add_u32 s59, s61, 7680
    buffer_load_dwordx4 v5, s[4:7], s59 offen lds
    v_mfma_f32_4x4x4_16b_bf16 v[112:115], v[148:149], v[148:149], v[112:115]
    v_mfma_f32_4x4x4_16b_bf16 v[120:123], v[24:25], v[148:149], v[120:123]
    v_mfma_f32_4x4x4_16b_bf16 v[116:119], v[150:151], v[150:151], v[116:119]
    v_mfma_f32_4x4x4_16b_bf16 v[124:127], v[24:25], v[150:151], v[124:127]
    s_waitcnt lgkmcnt(0)
    v_mfma_f32_32x32x16_bf16 v[64:79], v[96:99], v[152:155], v[64:79]
    ds_read_b128 v[156:159], v11 offset:24576
    ds_read_b64_tr_b16 v[104:105], v15 offset:24576
    ds_read_b64_tr_b16 v[106:107], v15 offset:24832
    ds_read_b64_tr_b16 v[108:109], v15 offset:28672
    ds_read_b64_tr_b16 v[110:111], v15 offset:28928
    v_mfma_f32_32x32x16_bf16 v[80:95], v[152:155], v[100:103], v[80:95]
    s_add_u32 m0, s63, 100352
    s_add_u32 s59, s61, 14848
    buffer_load_dwordx4 v4, s[4:7], s59 offen lds
    v_mfma_f32_4x4x4_16b_bf16 v[112:115], v[152:153], v[152:153], v[112:115]
    v_mfma_f32_4x4x4_16b_bf16 v[120:123], v[24:25], v[152:153], v[120:123]
    v_mfma_f32_4x4x4_16b_bf16 v[116:119], v[154:155], v[154:155], v[116:119]
    v_mfma_f32_4x4x4_16b_bf16 v[124:127], v[24:25], v[154:155], v[124:127]
    s_waitcnt lgkmcnt(0)
    v_mfma_f32_32x32x16_bf16 v[64:79], v[104:107], v[156:159], v[64:79]
    s_waitcnt vmcnt(12)
    s_barrier
    ds_read_b128 v[160:163], v8 offset:49152
    ds_read_b64_tr_b16 v[96:97], v12 offset:49152
    ds_read_b64_tr_b16 v[98:99], v12 offset:49408
    ds_read_b64_tr_b16 v[100:101], v12 offset:53248
    ds_read_b64_tr_b16 v[102:103], v12 offset:53504
    v_mfma_f32_32x32x16_bf16 v[80:95], v[156:159], v[108:111], v[80:95]
    s_add_u32 m0, s63, 101376
    s_add_u32 s59, s61, 22016
    buffer_load_dwordx4 v5, s[4:7], s59 offen lds
    v_mfma_f32_4x4x4_16b_bf16 v[112:115], v[156:157], v[156:157], v[112:115]
    v_mfma_f32_4x4x4_16b_bf16 v[120:123], v[24:25], v[156:157], v[120:123]
    v_mfma_f32_4x4x4_16b_bf16 v[116:119], v[158:159], v[158:159], v[116:119]
    v_mfma_f32_4x4x4_16b_bf16 v[124:127], v[24:25], v[158:159], v[124:127]
    s_waitcnt lgkmcnt(0)
    v_mfma_f32_32x32x16_bf16 v[64:79], v[96:99], v[160:163], v[64:79]
    ds_read_b128 v[164:167], v9 offset:49152
    ds_read_b64_tr_b16 v[104:105], v13 offset:49152
    ds_read_b64_tr_b16 v[106:107], v13 offset:49408
    ds_read_b64_tr_b16 v[108:109], v13 offset:53248
    ds_read_b64_tr_b16 v[110:111], v13 offset:53504
    v_mfma_f32_32x32x16_bf16 v[80:95], v[160:163], v[100:103], v[80:95]
    s_add_u32 m0, s62, 0
    s_add_u32 s59, s60, 861056
    buffer_load_dwordx4 v6, s[8:11], s59 offen lds
    s_add_u32 m0, s62, 4096
    s_add_u32 s59, s60, 861952
    buffer_load_dwordx4 v6, s[8:11], s59 offen lds
    v_mfma_f32_4x4x4_16b_bf16 v[112:115], v[160:161], v[160:161], v[112:115]
    v_mfma_f32_4x4x4_16b_bf16 v[120:123], v[24:25], v[160:161], v[120:123]
    v_mfma_f32_4x4x4_16b_bf16 v[116:119], v[162:163], v[162:163], v[116:119]
    v_mfma_f32_4x4x4_16b_bf16 v[124:127], v[24:25], v[162:163], v[124:127]
    v_mfma_f32_4x4x4_16b_bf16 v[240:243], v[24:25], v[96:97], v[240:243]
    v_mfma_f32_4x4x4_16b_bf16 v[248:251], v[24:25], v[100:101], v[248:251]
    v_mfma_f32_4x4x4_16b_bf16 v[244:247], v[24:25], v[98:99], v[244:247]
    v_mfma_f32_4x4x4_16b_bf16 v[252:255], v[24:25], v[102:103], v[252:255]
    s_waitcnt lgkmcnt(0)
    v_mfma_f32_32x32x16_bf16 v[64:79], v[104:107], v[164:167], v[64:79]
    ds_read_b128 v[168:171], v10 offset:49152
    ds_read_b64_tr_b16 v[96:97], v14 offset:49152
    ds_read_b64_tr_b16 v[98:99], v14 offset:49408
    ds_read_b64_tr_b16 v[100:101], v14 offset:53248
    ds_read_b64_tr_b16 v[102:103], v14 offset:53504
    v_mfma_f32_32x32x16_bf16 v[80:95], v[164:167], v[108:111], v[80:95]
    s_add_u32 m0, s63, 0
    s_add_u32 s59, s61, 640
    buffer_load_dwordx4 v4, s[4:7], s59 offen lds
    s_add_u32 m0, s63, 1024
    s_add_u32 s59, s61, 7808
    buffer_load_dwordx4 v5, s[4:7], s59 offen lds
    v_mfma_f32_4x4x4_16b_bf16 v[112:115], v[164:165], v[164:165], v[112:115]
    v_mfma_f32_4x4x4_16b_bf16 v[120:123], v[24:25], v[164:165], v[120:123]
    v_mfma_f32_4x4x4_16b_bf16 v[116:119], v[166:167], v[166:167], v[116:119]
    v_mfma_f32_4x4x4_16b_bf16 v[124:127], v[24:25], v[166:167], v[124:127]
    s_waitcnt lgkmcnt(0)
    v_mfma_f32_32x32x16_bf16 v[64:79], v[96:99], v[168:171], v[64:79]
    ds_read_b128 v[172:175], v11 offset:49152
    ds_read_b64_tr_b16 v[104:105], v15 offset:49152
    ds_read_b64_tr_b16 v[106:107], v15 offset:49408
    ds_read_b64_tr_b16 v[108:109], v15 offset:53248
    ds_read_b64_tr_b16 v[110:111], v15 offset:53504
    v_mfma_f32_32x32x16_bf16 v[80:95], v[168:171], v[100:103], v[80:95]
    s_add_u32 m0, s63, 2048
    s_add_u32 s59, s61, 14976
    buffer_load_dwordx4 v4, s[4:7], s59 offen lds
    v_mfma_f32_4x4x4_16b_bf16 v[112:115], v[168:169], v[168:169], v[112:115]
    v_mfma_f32_4x4x4_16b_bf16 v[120:123], v[24:25], v[168:169], v[120:123]
    v_mfma_f32_4x4x4_16b_bf16 v[116:119], v[170:171], v[170:171], v[116:119]
    v_mfma_f32_4x4x4_16b_bf16 v[124:127], v[24:25], v[170:171], v[124:127]
    s_waitcnt lgkmcnt(0)
    v_mfma_f32_32x32x16_bf16 v[64:79], v[104:107], v[172:175], v[64:79]
    s_waitcnt vmcnt(11)
    s_barrier
    v_add_u32 v8, 73728, v8
    v_add_u32 v9, 73728, v9
    v_add_u32 v10, 73728, v10
    v_add_u32 v11, 73728, v11
    v_add_u32 v12, 73728, v12
    v_add_u32 v13, 73728, v13
    v_add_u32 v14, 73728, v14
    v_add_u32 v15, 73728, v15
    ds_read_b128 v[176:179], v8 offset:0
    ds_read_b64_tr_b16 v[96:97], v12 offset:0
    ds_read_b64_tr_b16 v[98:99], v12 offset:256
    ds_read_b64_tr_b16 v[100:101], v12 offset:4096
    ds_read_b64_tr_b16 v[102:103], v12 offset:4352
    v_mfma_f32_32x32x16_bf16 v[80:95], v[172:175], v[108:111], v[80:95]
    s_add_u32 m0, s63, 3072
    s_add_u32 s59, s61, 22144
    buffer_load_dwordx4 v5, s[4:7], s59 offen lds
    v_mfma_f32_4x4x4_16b_bf16 v[112:115], v[172:173], v[172:173], v[112:115]
    v_mfma_f32_4x4x4_16b_bf16 v[120:123], v[24:25], v[172:173], v[120:123]
    v_mfma_f32_4x4x4_16b_bf16 v[116:119], v[174:175], v[174:175], v[116:119]
    v_mfma_f32_4x4x4_16b_bf16 v[124:127], v[24:25], v[174:175], v[124:127]
    s_waitcnt lgkmcnt(0)
    v_mfma_f32_32x32x16_bf16 v[64:79], v[96:99], v[176:179], v[64:79]
    ds_read_b128 v[180:183], v9 offset:0
    ds_read_b64_tr_b16 v[104:105], v13 offset:0
    ds_read_b64_tr_b16 v[106:107], v13 offset:256
    ds_read_b64_tr_b16 v[108:109], v13 offset:4096
    ds_read_b64_tr_b16 v[110:111], v13 offset:4352
    v_mfma_f32_32x32x16_bf16 v[80:95], v[176:179], v[100:103], v[80:95]
    s_add_u32 m0, s62, 24576
    s_add_u32 s59, s60, 1033088
    buffer_load_dwordx4 v6, s[8:11], s59 offen lds
    s_add_u32 m0, s62, 28672
    s_add_u32 s59, s60, 1033984
    buffer_load_dwordx4 v6, s[8:11], s59 offen lds
    v_mfma_f32_4x4x4_16b_bf16 v[112:115], v[176:177], v[176:177], v[112:115]
    v_mfma_f32_4x4x4_16b_bf16 v[120:123], v[24:25], v[176:177], v[120:123]
    v_mfma_f32_4x4x4_16b_bf16 v[116:119], v[178:179], v[178:179], v[116:119]
    v_mfma_f32_4x4x4_16b_bf16 v[124:127], v[24:25], v[178:179], v[124:127]
    v_mfma_f32_4x4x4_16b_bf16 v[240:243], v[24:25], v[96:97], v[240:243]
    v_mfma_f32_4x4x4_16b_bf16 v[248:251], v[24:25], v[100:101], v[248:251]
    v_mfma_f32_4x4x4_16b_bf16 v[244:247], v[24:25], v[98:99], v[244:247]
    v_mfma_f32_4x4x4_16b_bf16 v[252:255], v[24:25], v[102:103], v[252:255]
    s_waitcnt lgkmcnt(0)
    v_mfma_f32_32x32x16_bf16 v[64:79], v[104:107], v[180:183], v[64:79]
    ds_read_b128 v[184:187], v10 offset:0
    ds_read_b64_tr_b16 v[96:97], v14 offset:0
    ds_read_b64_tr_b16 v[98:99], v14 offset:256
    ds_read_b64_tr_b16 v[100:101], v14 offset:4096
    ds_read_b64_tr_b16 v[102:103], v14 offset:4352
    v_mfma_f32_32x32x16_bf16 v[80:95], v[180:183], v[108:111], v[80:95]
    s_add_u32 m0, s63, 24576
    s_add_u32 s59, s61, 768
    buffer_load_dwordx4 v4, s[4:7], s59 offen lds
    s_add_u32 m0, s63, 25600
    s_add_u32 s59, s61, 7936
    buffer_load_dwordx4 v5, s[4:7], s59 offen lds
    v_mfma_f32_4x4x4_16b_bf16 v[112:115], v[180:181], v[180:181], v[112:115]
    v_mfma_f32_4x4x4_16b_bf16 v[120:123], v[24:25], v[180:181], v[120:123]
    v_mfma_f32_4x4x4_16b_bf16 v[116:119], v[182:183], v[182:183], v[116:119]
    v_mfma_f32_4x4x4_16b_bf16 v[124:127], v[24:25], v[182:183], v[124:127]
    s_waitcnt lgkmcnt(0)
    v_mfma_f32_32x32x16_bf16 v[64:79], v[96:99], v[184:187], v[64:79]
    ds_read_b128 v[188:191], v11 offset:0
    ds_read_b64_tr_b16 v[104:105], v15 offset:0
    ds_read_b64_tr_b16 v[106:107], v15 offset:256
    ds_read_b64_tr_b16 v[108:109], v15 offset:4096
    ds_read_b64_tr_b16 v[110:111], v15 offset:4352
    v_mfma_f32_32x32x16_bf16 v[80:95], v[184:187], v[100:103], v[80:95]
    s_add_u32 m0, s63, 26624
    s_add_u32 s59, s61, 15104
    buffer_load_dwordx4 v4, s[4:7], s59 offen lds
    v_mfma_f32_4x4x4_16b_bf16 v[112:115], v[184:185], v[184:185], v[112:115]
    v_mfma_f32_4x4x4_16b_bf16 v[120:123], v[24:25], v[184:185], v[120:123]
    v_mfma_f32_4x4x4_16b_bf16 v[116:119], v[186:187], v[186:187], v[116:119]
    v_mfma_f32_4x4x4_16b_bf16 v[124:127], v[24:25], v[186:187], v[124:127]
    s_waitcnt lgkmcnt(0)
    v_mfma_f32_32x32x16_bf16 v[64:79], v[104:107], v[188:191], v[64:79]
    s_waitcnt vmcnt(11)
    s_barrier
    ds_read_b128 v[192:195], v8 offset:24576
    ds_read_b64_tr_b16 v[96:97], v12 offset:24576
    ds_read_b64_tr_b16 v[98:99], v12 offset:24832
    ds_read_b64_tr_b16 v[100:101], v12 offset:28672
    ds_read_b64_tr_b16 v[102:103], v12 offset:28928
    v_mfma_f32_32x32x16_bf16 v[80:95], v[188:191], v[108:111], v[80:95]
    s_add_u32 m0, s63, 27648
    s_add_u32 s59, s61, 22272
    buffer_load_dwordx4 v5, s[4:7], s59 offen lds
    v_mfma_f32_4x4x4_16b_bf16 v[112:115], v[188:189], v[188:189], v[112:115]
    v_mfma_f32_4x4x4_16b_bf16 v[120:123], v[24:25], v[188:189], v[120:123]
    v_mfma_f32_4x4x4_16b_bf16 v[116:119], v[190:191], v[190:191], v[116:119]
    v_mfma_f32_4x4x4_16b_bf16 v[124:127], v[24:25], v[190:191], v[124:127]
    s_waitcnt lgkmcnt(0)
    v_mfma_f32_32x32x16_bf16 v[64:79], v[96:99], v[192:195], v[64:79]
    ds_read_b128 v[196:199], v9 offset:24576
    ds_read_b64_tr_b16 v[104:105], v13 offset:24576
    ds_read_b64_tr_b16 v[106:107], v13 offset:24832
    ds_read_b64_tr_b16 v[108:109], v13 offset:28672
    ds_read_b64_tr_b16 v[110:111], v13 offset:28928
    v_mfma_f32_32x32x16_bf16 v[80:95], v[192:195], v[100:103], v[80:95]
    buffer_load_dword a244, v48, s[8:11], 0 offen
    buffer_load_dword a245, v47, s[16:19], 0 offen
    v_mfma_f32_4x4x4_16b_bf16 v[112:115], v[192:193], v[192:193], v[112:115]
    v_mfma_f32_4x4x4_16b_bf16 v[120:123], v[24:25], v[192:193], v[120:123]
    v_mfma_f32_4x4x4_16b_bf16 v[116:119], v[194:195], v[194:195], v[116:119]
    v_mfma_f32_4x4x4_16b_bf16 v[124:127], v[24:25], v[194:195], v[124:127]
    v_mfma_f32_4x4x4_16b_bf16 v[240:243], v[24:25], v[96:97], v[240:243]
    v_mfma_f32_4x4x4_16b_bf16 v[248:251], v[24:25], v[100:101], v[248:251]
    v_mfma_f32_4x4x4_16b_bf16 v[244:247], v[24:25], v[98:99], v[244:247]
    v_mfma_f32_4x4x4_16b_bf16 v[252:255], v[24:25], v[102:103], v[252:255]
    s_waitcnt lgkmcnt(0)
    v_mfma_f32_32x32x16_bf16 v[64:79], v[104:107], v[196:199], v[64:79]
    ds_read_b128 v[200:203], v10 offset:24576
    ds_read_b64_tr_b16 v[96:97], v14 offset:24576
    ds_read_b64_tr_b16 v[98:99], v14 offset:24832
    ds_read_b64_tr_b16 v[100:101], v14 offset:28672
    ds_read_b64_tr_b16 v[102:103], v14 offset:28928
    v_mfma_f32_32x32x16_bf16 v[80:95], v[196:199], v[108:111], v[80:95]
    s_mov_b32 s59, 0
    buffer_load_dword a246, v46, s[20:23], s59 offen
    s_mov_b32 s59, 6912
    buffer_load_dword a247, v46, s[20:23], s59 offen
    v_mfma_f32_4x4x4_16b_bf16 v[112:115], v[196:197], v[196:197], v[112:115]
    v_mfma_f32_4x4x4_16b_bf16 v[120:123], v[24:25], v[196:197], v[120:123]
    v_mfma_f32_4x4x4_16b_bf16 v[116:119], v[198:199], v[198:199], v[116:119]
    v_mfma_f32_4x4x4_16b_bf16 v[124:127], v[24:25], v[198:199], v[124:127]
    s_waitcnt lgkmcnt(0)
    v_mfma_f32_32x32x16_bf16 v[64:79], v[96:99], v[200:203], v[64:79]
    ds_read_b128 v[204:207], v11 offset:24576
    ds_read_b64_tr_b16 v[104:105], v15 offset:24576
    ds_read_b64_tr_b16 v[106:107], v15 offset:24832
    ds_read_b64_tr_b16 v[108:109], v15 offset:28672
    ds_read_b64_tr_b16 v[110:111], v15 offset:28928
    v_mfma_f32_32x32x16_bf16 v[80:95], v[200:203], v[100:103], v[80:95]
    s_mov_b32 s59, 13824
    buffer_load_dword a248, v46, s[20:23], s59 offen
    v_mfma_f32_4x4x4_16b_bf16 v[112:115], v[200:201], v[200:201], v[112:115]
    v_mfma_f32_4x4x4_16b_bf16 v[120:123], v[24:25], v[200:201], v[120:123]
    v_mfma_f32_4x4x4_16b_bf16 v[116:119], v[202:203], v[202:203], v[116:119]
    v_mfma_f32_4x4x4_16b_bf16 v[124:127], v[24:25], v[202:203], v[124:127]
    s_waitcnt lgkmcnt(0)
    v_mfma_f32_32x32x16_bf16 v[64:79], v[104:107], v[204:207], v[64:79]
    s_waitcnt vmcnt(11)
    s_barrier
    v_subrev_u32 v8, 73728, v8
    v_subrev_u32 v9, 73728, v9
    v_subrev_u32 v10, 73728, v10
    v_subrev_u32 v11, 73728, v11
    v_subrev_u32 v12, 73728, v12
    v_subrev_u32 v13, 73728, v13
    v_subrev_u32 v14, 73728, v14
    v_subrev_u32 v15, 73728, v15
    ds_read_b128 v[208:211], v8 offset:0
    ds_read_b64_tr_b16 v[96:97], v12 offset:0
    ds_read_b64_tr_b16 v[98:99], v12 offset:256
    ds_read_b64_tr_b16 v[100:101], v12 offset:4096
    ds_read_b64_tr_b16 v[102:103], v12 offset:4352
    v_mfma_f32_32x32x16_bf16 v[80:95], v[204:207], v[108:111], v[80:95]
    buffer_load_dword a249, v49, s[28:31], 0 offen
    v_mfma_f32_4x4x4_16b_bf16 v[112:115], v[204:205], v[204:205], v[112:115]
    v_mfma_f32_4x4x4_16b_bf16 v[120:123], v[24:25], v[204:205], v[120:123]
    v_mfma_f32_4x4x4_16b_bf16 v[116:119], v[206:207], v[206:207], v[116:119]
    v_mfma_f32_4x4x4_16b_bf16 v[124:127], v[24:25], v[206:207], v[124:127]
    s_waitcnt lgkmcnt(0)
    v_mfma_f32_32x32x16_bf16 v[64:79], v[96:99], v[208:211], v[64:79]
    ds_read_b128 v[212:215], v9 offset:0
    ds_read_b64_tr_b16 v[104:105], v13 offset:0
    ds_read_b64_tr_b16 v[106:107], v13 offset:256
    ds_read_b64_tr_b16 v[108:109], v13 offset:4096
    ds_read_b64_tr_b16 v[110:111], v13 offset:4352
    v_mfma_f32_32x32x16_bf16 v[80:95], v[208:211], v[100:103], v[80:95]
    v_mfma_f32_4x4x4_16b_bf16 v[112:115], v[208:209], v[208:209], v[112:115]
    v_mfma_f32_4x4x4_16b_bf16 v[120:123], v[24:25], v[208:209], v[120:123]
    v_mfma_f32_4x4x4_16b_bf16 v[116:119], v[210:211], v[210:211], v[116:119]
    v_mfma_f32_4x4x4_16b_bf16 v[124:127], v[24:25], v[210:211], v[124:127]
    v_mfma_f32_4x4x4_16b_bf16 v[240:243], v[24:25], v[96:97], v[240:243]
    v_mfma_f32_4x4x4_16b_bf16 v[248:251], v[24:25], v[100:101], v[248:251]
    v_mfma_f32_4x4x4_16b_bf16 v[244:247], v[24:25], v[98:99], v[244:247]
    v_mfma_f32_4x4x4_16b_bf16 v[252:255], v[24:25], v[102:103], v[252:255]
    s_waitcnt lgkmcnt(0)
    v_mfma_f32_32x32x16_bf16 v[64:79], v[104:107], v[212:215], v[64:79]
    ds_read_b128 v[216:219], v10 offset:0
    ds_read_b64_tr_b16 v[96:97], v14 offset:0
    ds_read_b64_tr_b16 v[98:99], v14 offset:256
    ds_read_b64_tr_b16 v[100:101], v14 offset:4096
    ds_read_b64_tr_b16 v[102:103], v14 offset:4352
    v_accvgpr_read_b32 v52, a161
    ds_read_b64_tr_b16 v[26:27], v52 offset:0
    ds_read_b64_tr_b16 v[28:29], v52 offset:448
    ds_read_b64_tr_b16 v[30:31], v52 offset:896
    ds_read_b64_tr_b16 v[32:33], v52 offset:1344
    v_mfma_f32_32x32x16_bf16 v[80:95], v[212:215], v[108:111], v[80:95]
    v_mfma_f32_4x4x4_16b_bf16 v[112:115], v[212:213], v[212:213], v[112:115]
    v_mfma_f32_4x4x4_16b_bf16 v[120:123], v[24:25], v[212:213], v[120:123]
    v_mfma_f32_4x4x4_16b_bf16 v[116:119], v[214:215], v[214:215], v[116:119]
    v_mfma_f32_4x4x4_16b_bf16 v[124:127], v[24:25], v[214:215], v[124:127]
    s_waitcnt lgkmcnt(4)
    v_mfma_f32_32x32x16_bf16 v[64:79], v[96:99], v[216:219], v[64:79]
    ds_read_b128 v[220:223], v11 offset:0
    ds_read_b64_tr_b16 v[104:105], v15 offset:0
    ds_read_b64_tr_b16 v[106:107], v15 offset:256
    ds_read_b64_tr_b16 v[108:109], v15 offset:4096
    ds_read_b64_tr_b16 v[110:111], v15 offset:4352
    v_mfma_f32_32x32x16_bf16 v[80:95], v[216:219], v[100:103], v[80:95]
    v_mfma_f32_4x4x4_16b_bf16 v[112:115], v[216:217], v[216:217], v[112:115]
    v_mfma_f32_4x4x4_16b_bf16 v[120:123], v[24:25], v[216:217], v[120:123]
    v_mfma_f32_4x4x4_16b_bf16 v[116:119], v[218:219], v[218:219], v[116:119]
    v_mfma_f32_4x4x4_16b_bf16 v[124:127], v[24:25], v[218:219], v[124:127]
    s_waitcnt lgkmcnt(0)
    v_mfma_f32_32x32x16_bf16 v[64:79], v[104:107], v[220:223], v[64:79]
    s_waitcnt vmcnt(6)
    s_barrier
    ds_read_b128 v[224:227], v8 offset:24576
    ds_read_b64_tr_b16 v[96:97], v12 offset:24576
    ds_read_b64_tr_b16 v[98:99], v12 offset:24832
    ds_read_b64_tr_b16 v[100:101], v12 offset:28672
    ds_read_b64_tr_b16 v[102:103], v12 offset:28928
    v_mfma_f32_32x32x16_bf16 v[80:95], v[220:223], v[108:111], v[80:95]
    v_mfma_f32_4x4x4_16b_bf16 v[112:115], v[220:221], v[220:221], v[112:115]
    v_mfma_f32_4x4x4_16b_bf16 v[120:123], v[24:25], v[220:221], v[120:123]
    v_mfma_f32_4x4x4_16b_bf16 v[116:119], v[222:223], v[222:223], v[116:119]
    v_mfma_f32_4x4x4_16b_bf16 v[124:127], v[24:25], v[222:223], v[124:127]
    s_waitcnt lgkmcnt(0)
    v_mfma_f32_32x32x16_bf16 v[64:79], v[96:99], v[224:227], v[64:79]
    ds_read_b128 v[228:231], v9 offset:24576
    ds_read_b64_tr_b16 v[104:105], v13 offset:24576
    ds_read_b64_tr_b16 v[106:107], v13 offset:24832
    ds_read_b64_tr_b16 v[108:109], v13 offset:28672
    ds_read_b64_tr_b16 v[110:111], v13 offset:28928
    v_mfma_f32_32x32x16_bf16 v[80:95], v[224:227], v[100:103], v[80:95]
    v_mfma_f32_4x4x4_16b_bf16 v[112:115], v[224:225], v[224:225], v[112:115]
    v_mfma_f32_4x4x4_16b_bf16 v[120:123], v[24:25], v[224:225], v[120:123]
    v_mfma_f32_4x4x4_16b_bf16 v[116:119], v[226:227], v[226:227], v[116:119]
    v_mfma_f32_4x4x4_16b_bf16 v[124:127], v[24:25], v[226:227], v[124:127]
    v_mfma_f32_4x4x4_16b_bf16 v[240:243], v[24:25], v[96:97], v[240:243]
    v_mfma_f32_4x4x4_16b_bf16 v[248:251], v[24:25], v[100:101], v[248:251]
    v_mfma_f32_4x4x4_16b_bf16 v[244:247], v[24:25], v[98:99], v[244:247]
    v_mfma_f32_4x4x4_16b_bf16 v[252:255], v[24:25], v[102:103], v[252:255]
    s_nop 3
    v_add_f32 v52, v240, v244
    v_add_f32 v53, v248, v252
    v_accvgpr_read_b32 v55, a162
    s_waitcnt lgkmcnt(0)
    v_mfma_f32_32x32x16_bf16 v[64:79], v[104:107], v[228:231], v[64:79]
    ds_read_b128 v[232:235], v10 offset:24576
    ds_read_b64_tr_b16 v[96:97], v14 offset:24576
    ds_read_b64_tr_b16 v[98:99], v14 offset:24832
    ds_read_b64_tr_b16 v[100:101], v14 offset:28672
    ds_read_b64_tr_b16 v[102:103], v14 offset:28928
    v_mfma_f32_32x32x16_bf16 v[80:95], v[228:231], v[108:111], v[80:95]
    v_mfma_f32_4x4x4_16b_bf16 v[112:115], v[228:229], v[228:229], v[112:115]
    v_mfma_f32_4x4x4_16b_bf16 v[120:123], v[24:25], v[228:229], v[120:123]
    v_mfma_f32_4x4x4_16b_bf16 v[116:119], v[230:231], v[230:231], v[116:119]
    v_mfma_f32_4x4x4_16b_bf16 v[124:127], v[24:25], v[230:231], v[124:127]
    v_permlane32_swap_b32 v52, v53
    v_add_f32 v52, v52, v53
    ds_write_b32 v55, v52 offset:2048
    s_waitcnt lgkmcnt(0)
    s_barrier
    s_waitcnt lgkmcnt(1)
    v_mfma_f32_32x32x16_bf16 v[64:79], v[96:99], v[232:235], v[64:79]
    ds_read_b128 v[236:239], v11 offset:24576
    ds_read_b64_tr_b16 v[104:105], v15 offset:24576
    ds_read_b64_tr_b16 v[106:107], v15 offset:24832
    ds_read_b64_tr_b16 v[108:109], v15 offset:28672
    ds_read_b64_tr_b16 v[110:111], v15 offset:28928
    ds_read_b128 v[56:59], v62 offset:2048
    v_mfma_f32_32x32x16_bf16 v[80:95], v[232:235], v[100:103], v[80:95]
    v_mfma_f32_4x4x4_16b_bf16 v[112:115], v[232:233], v[232:233], v[112:115]
    v_mfma_f32_4x4x4_16b_bf16 v[120:123], v[24:25], v[232:233], v[120:123]
    v_mfma_f32_4x4x4_16b_bf16 v[116:119], v[234:235], v[234:235], v[116:119]
    v_mfma_f32_4x4x4_16b_bf16 v[124:127], v[24:25], v[234:235], v[124:127]
    s_waitcnt lgkmcnt(1)
    v_mfma_f32_4x4x4_16b_bf16 v[112:115], v[236:237], v[236:237], v[112:115]
    v_mfma_f32_4x4x4_16b_bf16 v[120:123], v[24:25], v[236:237], v[120:123]
    v_mfma_f32_4x4x4_16b_bf16 v[116:119], v[238:239], v[238:239], v[116:119]
    v_mfma_f32_4x4x4_16b_bf16 v[124:127], v[24:25], v[238:239], v[124:127]
    s_waitcnt lgkmcnt(0)
    v_mfma_f32_32x32x16_bf16 v[64:79], v[104:107], v[236:239], v[64:79]
    v_add_f32 v56, v56, v57
    v_add_f32 v58, v58, v59
    v_add_f32 v56, v56, v58
    v_mov_b32 v57, v56
    v_mfma_f32_32x32x16_bf16 v[80:95], v[236:239], v[108:111], v[80:95]
    s_nop 0
    v_permlane32_swap_b32 v56, v57
    v_cndmask_b32 v58, v56, 0, s[72:73]
    v_cndmask_b32 v54, v57, 0, s[72:73]
    v_cvt_pk_bf16_f32 v34, v58, v58
    v_cvt_pk_bf16_f32 v38, v54, v54
    v_lshlrev_b32 v59, 16, v34
    v_lshlrev_b32 v55, 16, v38
    v_sub_f32 v59, v58, v59
    v_sub_f32 v55, v54, v55
    v_cvt_pk_bf16_f32 v35, v59, 0
    v_cvt_pk_bf16_f32 v39, v55, 0
    s_cmp_eq_u32 s68, 0
    s_cbranch_scc1 L_nohas
    v_add_f32 v112, v112, v116
    v_add_f32 v113, v113, v117
    v_add_f32 v114, v114, v118
    v_add_f32 v115, v115, v119
    v_add_f32 v52, v120, v124
    v_cndmask_b32 v53, v112, v113, s[76:77]
    v_cndmask_b32 v53, v53, v114, s[78:79]
    v_cndmask_b32 v53, v53, v115, s[80:81]
    v_accvgpr_read_b32 v56, a144
    v_accvgpr_read_b32 v57, a145
    v_permlane32_swap_b32 v52, v53
    v_add_f32 v52, v52, v53
    v_mov_b32 v53, v52
    s_nop 0
    s_nop 0
    v_permlane32_swap_b32 v52, v53
    v_mul_f32 v52, 0x3b124925, v52
    v_mul_f32 v53, 0x3b124925, v53
    v_sub_f32 v54, 0, v52
    v_fma_f32 v53, -v52, v52, v53
    v_cndmask_b32 v54, v54, 0, s[72:73]
    v_add_f32 v53, 0x3727c5ac, v53
    v_cvt_pk_bf16_f32 v43, v54, 0
    v_rsq_f32 v50, v53
    v_lshlrev_b32 v55, 16, v43
    v_sub_f32 v55, v54, v55
    v_cvt_pk_bf16_f32 v42, v54, v55
    ds_write_b32 v56, v50 offset:3072
    v_mul_f32 v51, 0x3fb8aa3b, v50
    v_mfma_f32_32x32x16_bf16 v[64:79], v[34:37], v[42:45], v[64:79]
    v_mfma_f32_32x32x16_bf16 v[80:95], v[42:45], v[38:41], v[80:95]
    s_add_u32 m0, s82, 0
    s_add_u32 s59, s83, 0
    buffer_load_dwordx4 v6, s[8:11], s59 offen lds
    s_waitcnt lgkmcnt(0)
    ds_read_b128 v[112:115], v57 offset:3072
    ds_read_b128 v[116:119], v57 offset:3104
    ds_read_b128 v[120:123], v57 offset:3136
    ds_read_b128 v[124:127], v57 offset:3168
    s_barrier
    s_nop 1
    v_cndmask_b32 v76, v76, 0, s[72:73]
    v_cndmask_b32 v77, v77, 0, s[72:73]
    v_cndmask_b32 v78, v78, 0, s[72:73]
    v_cndmask_b32 v79, v79, 0, s[72:73]
    v_cvt_pk_bf16_f32 v248, v64, v65
    v_cvt_pk_bf16_f32 v249, v66, v67
    v_cvt_pk_bf16_f32 v250, v68, v69
    v_cvt_pk_bf16_f32 v251, v70, v71
    v_cvt_pk_bf16_f32 v252, v72, v73
    v_cvt_pk_bf16_f32 v253, v74, v75
    v_cvt_pk_bf16_f32 v254, v76, v77
    v_cvt_pk_bf16_f32 v255, v78, v79
    v_mfma_f32_32x32x16_bf16 v[96:111], v[26:29], v[248:251], 0
    s_nop 0
    v_mfma_f32_32x32x16_bf16 v[96:111], v[30:33], v[252:255], v[96:111]
    s_waitcnt lgkmcnt(0)
    v_mul_f32 v80, v80, v112
    v_mul_f32 v81, v81, v113
    v_mul_f32 v82, v82, v114
    v_mul_f32 v83, v83, v115
    v_mul_f32 v84, v84, v116
    v_mul_f32 v85, v85, v117
    v_mul_f32 v86, v86, v118
    v_mul_f32 v87, v87, v119
    v_mul_f32 v88, v88, v120
    v_mul_f32 v89, v89, v121
    v_mul_f32 v90, v90, v122
    v_mul_f32 v91, v91, v123
    v_mul_f32 v92, v92, v124
    v_mul_f32 v93, v93, v125
    v_mul_f32 v94, v94, v126
    v_mul_f32 v95, v95, v127
    v_cmp_eq_u32 vcc, 28, v2
    v_cvt_pk_bf16_f32 v240, v80, v81
    v_cvt_pk_bf16_f32 v241, v82, v83
    v_cvt_pk_bf16_f32 v242, v84, v85
    v_cvt_pk_bf16_f32 v243, v86, v87
    v_cvt_pk_bf16_f32 v244, v88, v89
    v_cvt_pk_bf16_f32 v245, v90, v91
    v_cvt_pk_bf16_f32 v246, v92, v93
    v_cvt_pk_bf16_f32 v247, v94, v95
    v_cndmask_b32 v60, 0, v24, vcc
    v_cndmask_b32 v240, v240, v60, s[74:75]
    v_cndmask_b32 v241, v241, v60, s[74:75]
    v_cndmask_b32 v242, v242, v60, s[74:75]
    v_cndmask_b32 v243, v243, v60, s[74:75]
    v_cndmask_b32 v244, v244, v60, s[74:75]
    v_cndmask_b32 v245, v245, v60, s[74:75]
    v_cndmask_b32 v246, v246, v60, s[74:75]
    v_cndmask_b32 v247, v247, v60, s[74:75]
    v_cndmask_b32 v108, v108, v96, s[72:73]
    s_add_u32 m0, s82, 1024
    s_add_u32 s59, s83, 43008
    buffer_load_dwordx4 v6, s[8:11], s59 offen lds
    v_cndmask_b32 v109, v109, v96, s[72:73]
    v_cndmask_b32 v110, v110, v96, s[72:73]
    v_cndmask_b32 v111, v111, v96, s[72:73]
    v_max3_f32 v52, v96, v97, v98
    v_min3_f32 v53, v96, v97, v98
    v_max3_f32 v52, v52, v99, v100
    v_min3_f32 v53, v53, v99, v100
    v_max3_f32 v52, v52, v101, v102
    v_min3_f32 v53, v53, v101, v102
    v_max3_f32 v52, v52, v103, v104
    v_min3_f32 v53, v53, v103, v104
    v_max3_f32 v52, v52, v105, v106
    v_min3_f32 v53, v53, v105, v106
    v_max3_f32 v52, v52, v107, v108
    v_min3_f32 v53, v53, v107, v108
    v_max3_f32 v52, v52, v109, v110
    v_min3_f32 v53, v53, v109, v110
    v_max_f32 v52, v52, v111
    v_min_f32 v53, v53, v111
    v_sub_f32 v53, 0, v53
    s_nop 1
    v_permlane32_swap_b32 v52, v53
    v_max_f32 v52, v52, v53
    v_mov_b32 v53, v52
    s_nop 1
    v_permlane32_swap_b32 v52, v53
    v_mul_f32 v56, v51, v52
    v_mul_f32 v58, v51, v53
    v_sub_f32 v55, 0, v51
    v_cndmask_b32 v54, v51, v55, s[70:71]
    v_mov_b32 v55, v56
    v_cndmask_b32 v56, v56, v58, s[70:71]
    v_cndmask_b32 v58, v58, v55, s[70:71]
    v_pk_fma_f32 v[112:113], v[96:97], v[54:55], v[56:57] op_sel_hi:[1,0,0] neg_lo:[0,0,1] neg_hi:[0,0,1]
    v_pk_fma_f32 v[114:115], v[98:99], v[54:55], v[56:57] op_sel_hi:[1,0,0] neg_lo:[0,0,1] neg_hi:[0,0,1]
    v_pk_fma_f32 v[116:117], v[100:101], v[54:55], v[56:57] op_sel_hi:[1,0,0] neg_lo:[0,0,1] neg_hi:[0,0,1]
    v_pk_fma_f32 v[118:119], v[102:103], v[54:55], v[56:57] op_sel_hi:[1,0,0] neg_lo:[0,0,1] neg_hi:[0,0,1]
    v_pk_fma_f32 v[120:121], v[104:105], v[54:55], v[56:57] op_sel_hi:[1,0,0] neg_lo:[0,0,1] neg_hi:[0,0,1]
    v_pk_fma_f32 v[122:123], v[106:107], v[54:55], v[56:57] op_sel_hi:[1,0,0] neg_lo:[0,0,1] neg_hi:[0,0,1]
    v_pk_fma_f32 v[124:125], v[108:109], v[54:55], v[56:57] op_sel_hi:[1,0,0] neg_lo:[0,0,1] neg_hi:[0,0,1]
    v_pk_fma_f32 v[126:127], v[110:111], v[54:55], v[56:57] op_sel_hi:[1,0,0] neg_lo:[0,0,1] neg_hi:[0,0,1]
    v_pk_fma_f32 v[64:65], v[96:97], v[54:55], v[58:59] op_sel_hi:[1,0,0] neg_lo:[0,1,1] neg_hi:[0,1,1]
    v_pk_fma_f32 v[66:67], v[98:99], v[54:55], v[58:59] op_sel_hi:[1,0,0] neg_lo:[0,1,1] neg_hi:[0,1,1]
    v_pk_fma_f32 v[68:69], v[100:101], v[54:55], v[58:59] op_sel_hi:[1,0,0] neg_lo:[0,1,1] neg_hi:[0,1,1]
    v_pk_fma_f32 v[70:71], v[102:103], v[54:55], v[58:59] op_sel_hi:[1,0,0] neg_lo:[0,1,1] neg_hi:[0,1,1]
    v_pk_fma_f32 v[72:73], v[104:105], v[54:55], v[58:59] op_sel_hi:[1,0,0] neg_lo:[0,1,1] neg_hi:[0,1,1]
    v_pk_fma_f32 v[74:75], v[106:107], v[54:55], v[58:59] op_sel_hi:[1,0,0] neg_lo:[0,1,1] neg_hi:[0,1,1]
    v_pk_fma_f32 v[76:77], v[108:109], v[54:55], v[58:59] op_sel_hi:[1,0,0] neg_lo:[0,1,1] neg_hi:[0,1,1]
    v_pk_fma_f32 v[78:79], v[110:111], v[54:55], v[58:59] op_sel_hi:[1,0,0] neg_lo:[0,1,1] neg_hi:[0,1,1]
    v_exp_f32 v112, v112
    v_exp_f32 v113, v113
    v_exp_f32 v114, v114
    v_exp_f32 v115, v115
    v_exp_f32 v116, v116
    v_exp_f32 v117, v117
    v_exp_f32 v118, v118
    s_add_u32 m0, s82, 2048
    s_add_u32 s59, s83, 86016
    buffer_load_dwordx4 v6, s[8:11], s59 offen lds
    v_exp_f32 v119, v119
    v_exp_f32 v120, v120
    v_exp_f32 v121, v121
    v_exp_f32 v122, v122
    v_exp_f32 v123, v123
    v_exp_f32 v124, v124
    v_exp_f32 v125, v125
    v_exp_f32 v126, v126
    v_exp_f32 v127, v127
    v_cndmask_b32 v124, v124, 0, s[72:73]
    v_cndmask_b32 v125, v125, 0, s[72:73]
    v_cndmask_b32 v126, v126, 0, s[72:73]
    v_cndmask_b32 v127, v127, 0, s[72:73]
    v_pk_add_f32 v[96:97], v[112:113], v[114:115]
    v_pk_add_f32 v[98:99], v[116:117], v[118:119]
    v_pk_add_f32 v[100:101], v[120:121], v[122:123]
    v_pk_add_f32 v[102:103], v[124:125], v[126:127]
    v_pk_add_f32 v[96:97], v[96:97], v[98:99]
    v_pk_add_f32 v[100:101], v[100:101], v[102:103]
    v_pk_add_f32 v[96:97], v[96:97], v[100:101]
    v_add_f32 v96, v96, v97
    v_mov_b32 v97, v96
    s_nop 1
    v_permlane32_swap_b32 v96, v97
    v_add_f32 v96, v96, v97
    v_rcp_f32 v96, v96
    s_nop 0
    v_pk_mul_f32 v[112:113], v[112:113], v[96:97] op_sel_hi:[1,0]
    v_pk_mul_f32 v[114:115], v[114:115], v[96:97] op_sel_hi:[1,0]
    v_pk_mul_f32 v[116:117], v[116:117], v[96:97] op_sel_hi:[1,0]
    v_pk_mul_f32 v[118:119], v[118:119], v[96:97] op_sel_hi:[1,0]
    v_pk_mul_f32 v[120:121], v[120:121], v[96:97] op_sel_hi:[1,0]
    v_pk_mul_f32 v[122:123], v[122:123], v[96:97] op_sel_hi:[1,0]
    v_pk_mul_f32 v[124:125], v[124:125], v[96:97] op_sel_hi:[1,0]
    v_pk_mul_f32 v[126:127], v[126:127], v[96:97] op_sel_hi:[1,0]
    v_cvt_pk_bf16_f32 v80, v112, v113
    v_cvt_pk_bf16_f32 v81, v114, v115
    v_cvt_pk_bf16_f32 v82, v116, v117
    v_cvt_pk_bf16_f32 v83, v118, v119
    v_cvt_pk_bf16_f32 v84, v120, v121
    v_cvt_pk_bf16_f32 v85, v122, v123
    v_cvt_pk_bf16_f32 v86, v124, v125
    v_cvt_pk_bf16_f32 v87, v126, v127
    v_mfma_f32_32x32x16_bf16 v[96:111], v[80:83], v[16:19], 0
    s_nop 0
    v_mfma_f32_32x32x16_bf16 v[96:111], v[84:87], v[20:23], v[96:111]
    v_exp_f32 v64, v64
    s_add_u32 m0, s82, 3072
    s_add_u32 s59, s83, 129024
    buffer_load_dwordx4 v6, s[8:11], s59 offen lds
    v_exp_f32 v65, v65
    v_exp_f32 v66, v66
    v_exp_f32 v67, v67
    v_exp_f32 v68, v68
    v_exp_f32 v69, v69
    v_exp_f32 v70, v70
    v_exp_f32 v71, v71
    v_exp_f32 v72, v72
    v_exp_f32 v73, v73
    v_exp_f32 v74, v74
    v_exp_f32 v75, v75
    v_exp_f32 v76, v76
    v_exp_f32 v77, v77
    v_exp_f32 v78, v78
    v_exp_f32 v79, v79
    v_cndmask_b32 v76, v76, 0, s[72:73]
    v_cndmask_b32 v77, v77, 0, s[72:73]
    v_cndmask_b32 v78, v78, 0, s[72:73]
    v_cndmask_b32 v79, v79, 0, s[72:73]
    v_pk_add_f32 v[112:113], v[64:65], v[66:67]
    v_pk_add_f32 v[114:115], v[68:69], v[70:71]
    v_pk_add_f32 v[116:117], v[72:73], v[74:75]
    v_pk_add_f32 v[118:119], v[76:77], v[78:79]
    v_pk_add_f32 v[112:113], v[112:113], v[114:115]
    v_pk_add_f32 v[116:117], v[116:117], v[118:119]
    v_pk_add_f32 v[112:113], v[112:113], v[116:117]
    v_add_f32 v112, v112, v113
    v_mov_b32 v113, v112
    s_nop 1
    v_permlane32_swap_b32 v112, v113
    v_add_f32 v112, v112, v113
    v_rcp_f32 v112, v112
    s_nop 0
    v_pk_mul_f32 v[64:65], v[64:65], v[112:113] op_sel_hi:[1,0]
    v_pk_mul_f32 v[66:67], v[66:67], v[112:113] op_sel_hi:[1,0]
    v_pk_mul_f32 v[68:69], v[68:69], v[112:113] op_sel_hi:[1,0]
    v_pk_mul_f32 v[70:71], v[70:71], v[112:113] op_sel_hi:[1,0]
    v_pk_mul_f32 v[72:73], v[72:73], v[112:113] op_sel_hi:[1,0]
    v_pk_mul_f32 v[74:75], v[74:75], v[112:113] op_sel_hi:[1,0]
    v_pk_mul_f32 v[76:77], v[76:77], v[112:113] op_sel_hi:[1,0]
    v_pk_mul_f32 v[78:79], v[78:79], v[112:113] op_sel_hi:[1,0]
    v_cvt_pk_bf16_f32 v88, v64, v65
    v_cvt_pk_bf16_f32 v89, v66, v67
    v_cvt_pk_bf16_f32 v90, v68, v69
    v_cvt_pk_bf16_f32 v91, v70, v71
    v_cvt_pk_bf16_f32 v92, v72, v73
    s_add_u32 m0, s82, 4096
    s_add_u32 s59, s83, 172032
    buffer_load_dwordx4 v6, s[8:11], s59 offen lds
    v_cvt_pk_bf16_f32 v93, v74, v75
    v_cvt_pk_bf16_f32 v94, v76, v77
    v_cvt_pk_bf16_f32 v95, v78, v79
    v_mfma_f32_32x32x16_bf16 v[112:127], v[88:91], v[16:19], 0
    s_nop 0
    v_mfma_f32_32x32x16_bf16 v[112:127], v[92:95], v[20:23], v[112:127]
    v_cvt_pk_bf16_f32 v64, v96, v97
    v_cvt_pk_bf16_f32 v65, v98, v99
    v_cvt_pk_bf16_f32 v66, v100, v101
    v_cvt_pk_bf16_f32 v67, v102, v103
    v_cvt_pk_bf16_f32 v68, v104, v105
    v_cvt_pk_bf16_f32 v69, v106, v107
    v_cvt_pk_bf16_f32 v70, v108, v109
    v_cvt_pk_bf16_f32 v71, v110, v111
    v_mfma_f32_32x32x16_bf16 v[96:111], v[64:67], v[240:243], 0
    s_nop 0
    v_mfma_f32_32x32x16_bf16 v[96:111], v[68:71], v[244:247], v[96:111]
    v_accvgpr_read_b32 v53, a140
    v_accvgpr_read_b32 v54, a141
    v_accvgpr_read_b32 v55, a142
    v_accvgpr_read_b32 v56, a143
    v_accvgpr_read_b32 v57, a139
    v_mov_b32 v58, s49
    v_cvt_pk_bf16_f32 v72, v112, v113
    v_cvt_pk_bf16_f32 v73, v114, v115
    v_cvt_pk_bf16_f32 v74, v116, v117
    v_cvt_pk_bf16_f32 v75, v118, v119
    v_cvt_pk_bf16_f32 v76, v120, v121
    v_cvt_pk_bf16_f32 v77, v122, v123
    v_cvt_pk_bf16_f32 v78, v124, v125
    v_cvt_pk_bf16_f32 v79, v126, v127
    v_mfma_f32_32x32x16_bf16 v[112:127], v[72:75], v[240:243], 0
    s_nop 0
    v_mfma_f32_32x32x16_bf16 v[112:127], v[76:79], v[244:247], v[112:127]
    ds_write_b128 v53, v[104:107] offset:0
    ds_write_b128 v53, v[108:111] offset:1024
    s_nop 9
    ds_write_b128 v54, v[112:115] offset:0
    ds_write_b128 v54, v[116:119] offset:1024
    ds_write_b128 v55, v[120:123] offset:0
    ds_write_b128 v55, v[124:127] offset:1024
    s_waitcnt lgkmcnt(0)
    s_barrier
    ds_read_b128 v[64:67], v56 offset:0
    ds_read_b128 v[68:71], v56 offset:1024
    ds_read_b128 v[72:75], v56 offset:2048
    ds_read_b128 v[76:79], v56 offset:3072
    ds_read_b128 v[80:83], v56 offset:4096
    ds_read_b128 v[84:87], v56 offset:5120
    s_waitcnt lgkmcnt(4)
    v_pk_add_f32 v[96:97], v[96:97], v[64:65]
    v_pk_add_f32 v[98:99], v[98:99], v[66:67]
    v_pk_add_f32 v[100:101], v[100:101], v[68:69]
    v_pk_add_f32 v[102:103], v[102:103], v[70:71]
    s_waitcnt lgkmcnt(0)
    v_pk_add_f32 v[72:73], v[72:73], v[80:81]
    v_pk_add_f32 v[74:75], v[74:75], v[82:83]
    v_pk_add_f32 v[76:77], v[76:77], v[84:85]
    v_pk_add_f32 v[78:79], v[78:79], v[86:87]
    v_pk_add_f32 v[96:97], v[96:97], v[72:73]
    v_pk_add_f32 v[98:99], v[98:99], v[74:75]
    v_pk_add_f32 v[100:101], v[100:101], v[76:77]
    v_pk_add_f32 v[102:103], v[102:103], v[78:79]
    v_cvt_pk_bf16_f32 v72, v96, v97
    v_cvt_pk_bf16_f32 v73, v98, v99
    v_cvt_pk_bf16_f32 v74, v100, v101
    v_cvt_pk_bf16_f32 v75, v102, v103
    buffer_store_dwordx4 v[72:75], v62, s[40:43], s101 offen sc1
    s_add_u32 m0, s82, 5120
    s_add_u32 s59, s83, 215040
    buffer_load_dwordx4 v6, s[8:11], s59 offen lds
    s_add_u32 m0, s82, 6144
    s_add_u32 s59, s83, 258048
    buffer_load_dwordx4 v6, s[8:11], s59 offen lds
    v_accvgpr_read_b32 v4, a128
    v_accvgpr_read_b32 v5, a129
    s_add_u32 m0, s92, 14336
    s_add_u32 s59, s100, 200704
    buffer_load_dwordx4 v5, s[20:23], s59 offen lds
    s_add_u32 m0, s92, 15360
    s_add_u32 s59, s100, 215040
    buffer_load_dwordx4 v5, s[20:23], s59 offen lds
    s_add_u32 m0, s92, 16384
    s_add_u32 s59, s100, 229376
    buffer_load_dwordx4 v5, s[20:23], s59 offen lds
    s_add_u32 m0, s92, 17408
    s_add_u32 s59, s100, 243712
    buffer_load_dwordx4 v5, s[20:23], s59 offen lds
    s_waitcnt vmcnt(6)
    buffer_store_dword v58, v57, s[40:43], 0 offen sc1
    v_and_b32 v58, 15, v1
    v_lshrrev_b32 v58, 2, v58
    v_bfe_u32 v59, v1, 4, 1
    v_and_b32 v60, 3, v1
    v_lshl_add_u32 v52, v3, 2, v58
    v_and_b32 v53, 1, v1
    v_lshlrev_b32 v55, 8, v52
    v_lshl_add_u32 v55, v53, 3, v55
    v_lshlrev_b32 v52, 7, v52
    v_lshl_add_u32 v52, v53, 3, v52
    v_lshlrev_b32 v53, 1, v59
    v_bfe_u32 v54, v1, 1, 1
    v_add_u32 v53, v53, v54
    v_bfe_u32 v54, v1, 3, 1
    v_lshlrev_b32 v54, 2, v54
    v_xor_b32 v54, v53, v54
    s_and_b32 s53, s47, 1
    s_lshl_b32 s53, s53, 2
    v_xor_b32 v54, s53, v54
    v_lshl_add_u32 v56, v54, 4, v52
    v_xor_b32 v54, 4, v54
    v_lshl_add_u32 v57, v54, 4, v52
    v_add_u32 v8, s92, v56
    v_add_u32 v9, s92, v57
    v_add_u32 v10, s93, v56
    v_add_u32 v11, s93, v57
    v_add_u32 v55, 8192, v55
    v_lshlrev_b32 v54, 2, v58
    v_xor_b32 v53, v53, v54
    v_xor_b32 v54, 0, v53
    v_lshl_add_u32 v52, v54, 4, v55
    v_accvgpr_write_b32 a134, v52
    v_xor_b32 v54, 4, v53
    v_lshl_add_u32 v52, v54, 4, v55
    v_accvgpr_write_b32 a135, v52
    v_xor_b32 v54, 8, v53
    v_lshl_add_u32 v52, v54, 4, v55
    v_accvgpr_write_b32 a136, v52
    v_xor_b32 v54, 12, v53
    v_lshl_add_u32 v52, v54, 4, v55
    v_accvgpr_write_b32 a137, v52
    v_and_b32 v58, 15, v1
    v_lshrrev_b32 v58, 2, v58
    v_bfe_u32 v59, v1, 4, 1
    v_and_b32 v60, 3, v1
    s_lshl_b32 s54, s46, 2
    s_add_u32 s54, s54, s47
    s_lshl_b32 s54, s54, 6
    s_add_u32 s54, s54, 4096
    v_and_b32 v52, 15, v1
    v_lshlrev_b32 v52, 2, v52
    v_add_u32 v52, s54, v52
    v_accvgpr_write_b32 a146, v52
    s_lshl_b32 s53, s47, 10
    v_add_u32 v52, s53, v62
    v_accvgpr_write_b32 a163, v52
    s_lshr_b32 s53, s48, 5
    s_add_u32 s53, s53, s47
    s_lshl_b32 s53, s53, 4
    s_add_u32 s53, s53, s46
    s_lshl_b32 s54, s53, 2
    s_add_u32 s54, s54, 8192
    v_mov_b32 v52, 0x80000000
    v_writelane_b32 v52, s54, 0
    v_accvgpr_write_b32 a147, v52
    s_lshr_b32 s53, s48, 5
    s_add_u32 s53, s53, s47
    s_lshl_b32 s53, s53, 4
    s_add_u32 s53, s53, s46
    s_lshl_b32 s53, s53, 11
    s_add_u32 s84, s53, 2097152
    v_lshlrev_b32 v52, 7, v1
    v_cmp_gt_u32 vcc, 16, v1
    v_mov_b32 v53, 0x80000000
    s_nop 0
    v_cndmask_b32 v52, v53, v52, vcc
    buffer_load_dword a255, v52, s[40:43], s84 offen
    s_lshl_b32 s55, s44, 8
    s_add_u32 s55, s55, 1024
    v_lshlrev_b32 v52, 3, v2
    buffer_load_dwordx2 v[88:89], v52, s[40:43], s55 offen sc1
    v_add_u32 v12, 106496, v12
    v_add_u32 v13, 106496, v13
    v_add_u32 v14, 106496, v14
    v_add_u32 v15, 106496, v15
    v_mov_b32 v64, 0
    v_mov_b32 v65, 0
    v_mov_b32 v66, 0
    v_mov_b32 v67, 0
    v_mov_b32 v68, 0
    v_mov_b32 v69, 0
    v_mov_b32 v70, 0
    v_mov_b32 v71, 0
    v_mov_b32 v72, 0
    v_mov_b32 v73, 0
    v_mov_b32 v74, 0
    v_mov_b32 v75, 0
    v_mov_b32 v76, 0
    v_mov_b32 v77, 0
    v_mov_b32 v78, 0
    v_mov_b32 v79, 0
    v_mov_b32 v112, 0
    v_mov_b32 v113, 0
    v_mov_b32 v114, 0
    v_mov_b32 v115, 0
    v_mov_b32 v116, 0
    v_mov_b32 v117, 0
    v_mov_b32 v118, 0
    v_mov_b32 v119, 0
    v_mov_b32 v48, 0
    v_mov_b32 v49, 0
    v_accvgpr_read_b32 v55, a162
    s_waitcnt vmcnt(7)
    s_barrier
    ds_read_b64_tr_b16 v[96:97], v12 offset:0
    ds_read_b64_tr_b16 v[98:99], v12 offset:256
    ds_read_b64_tr_b16 v[100:101], v13 offset:0
    ds_read_b64_tr_b16 v[102:103], v13 offset:256
    ds_read_b64_tr_b16 v[104:105], v14 offset:0
    ds_read_b64_tr_b16 v[106:107], v14 offset:256
    s_waitcnt lgkmcnt(4)
    v_mfma_f32_32x32x16_bf16 v[64:79], v[96:99], v[128:131], v[64:79]
    s_add_u32 m0, s92, 18432
    s_add_u32 s59, s100, 258048
    buffer_load_dwordx4 v5, s[20:23], s59 offen lds
    v_mfma_f32_4x4x4_16b_bf16 v[112:115], v[24:25], v[96:97], v[112:115]
    v_mfma_f32_4x4x4_16b_bf16 v[116:119], v[24:25], v[98:99], v[116:119]
    ds_read_b64_tr_b16 v[96:97], v15 offset:0
    ds_read_b64_tr_b16 v[98:99], v15 offset:256
    s_waitcnt lgkmcnt(4)
    v_mfma_f32_32x32x16_bf16 v[64:79], v[100:103], v[132:135], v[64:79]
    s_add_u32 m0, s92, 19456
    s_add_u32 s59, s100, 272384
    buffer_load_dwordx4 v5, s[20:23], s59 offen lds
    ds_read_b64_tr_b16 v[100:101], v12 offset:4096
    ds_read_b64_tr_b16 v[102:103], v12 offset:4352
    s_waitcnt lgkmcnt(4)
    v_mfma_f32_32x32x16_bf16 v[64:79], v[104:107], v[136:139], v[64:79]
    s_add_u32 m0, s92, 20480
    s_add_u32 s59, s100, 286720
    buffer_load_dwordx4 v5, s[20:23], s59 offen lds
    ds_read_b64_tr_b16 v[104:105], v13 offset:4096
    ds_read_b64_tr_b16 v[106:107], v13 offset:4352
    s_waitcnt lgkmcnt(4)
    v_mfma_f32_32x32x16_bf16 v[64:79], v[96:99], v[140:143], v[64:79]
    s_add_u32 m0, s92, 21504
    s_add_u32 s59, s100, 301056
    buffer_load_dwordx4 v5, s[20:23], s59 offen lds
    ds_read_b64_tr_b16 v[96:97], v14 offset:4096
    ds_read_b64_tr_b16 v[98:99], v14 offset:4352
    s_waitcnt lgkmcnt(4)
    v_mfma_f32_32x32x16_bf16 v[64:79], v[100:103], v[144:147], v[64:79]
    s_add_u32 m0, s92, 22528
    s_add_u32 s59, s100, 315392
    buffer_load_dwordx4 v5, s[20:23], s59 offen lds
    v_mfma_f32_4x4x4_16b_bf16 v[112:115], v[24:25], v[100:101], v[112:115]
    v_mfma_f32_4x4x4_16b_bf16 v[116:119], v[24:25], v[102:103], v[116:119]
    ds_read_b64_tr_b16 v[100:101], v15 offset:4096
    ds_read_b64_tr_b16 v[102:103], v15 offset:4352
    s_waitcnt lgkmcnt(4)
    v_mfma_f32_32x32x16_bf16 v[64:79], v[104:107], v[148:151], v[64:79]
    s_add_u32 m0, s92, 23552
    s_add_u32 s59, s100, 329728
    buffer_load_dwordx4 v5, s[20:23], s59 offen lds
    ds_read_b64_tr_b16 v[104:105], v12 offset:8192
    ds_read_b64_tr_b16 v[106:107], v12 offset:8448
    s_waitcnt lgkmcnt(4)
    v_mfma_f32_32x32x16_bf16 v[64:79], v[96:99], v[152:155], v[64:79]
    s_add_u32 m0, s92, 24576
    s_add_u32 s59, s100, 344064
    buffer_load_dwordx4 v5, s[20:23], s59 offen lds
    ds_read_b64_tr_b16 v[96:97], v13 offset:8192
    ds_read_b64_tr_b16 v[98:99], v13 offset:8448
    s_waitcnt lgkmcnt(4)
    v_mfma_f32_32x32x16_bf16 v[64:79], v[100:103], v[156:159], v[64:79]
    s_add_u32 m0, s92, 25600
    s_add_u32 s59, s100, 358400
    buffer_load_dwordx4 v5, s[20:23], s59 offen lds
    ds_read_b64_tr_b16 v[100:101], v14 offset:8192
    ds_read_b64_tr_b16 v[102:103], v14 offset:8448
    s_waitcnt lgkmcnt(4)
    v_mfma_f32_32x32x16_bf16 v[64:79], v[104:107], v[160:163], v[64:79]
    s_add_u32 m0, s92, 26624
    s_add_u32 s59, s100, 372736
    buffer_load_dwordx4 v5, s[20:23], s59 offen lds
    v_mfma_f32_4x4x4_16b_bf16 v[112:115], v[24:25], v[104:105], v[112:115]
    v_mfma_f32_4x4x4_16b_bf16 v[116:119], v[24:25], v[106:107], v[116:119]
    ds_read_b64_tr_b16 v[104:105], v15 offset:8192
    ds_read_b64_tr_b16 v[106:107], v15 offset:8448
    s_waitcnt lgkmcnt(4)
    v_mfma_f32_32x32x16_bf16 v[64:79], v[96:99], v[164:167], v[64:79]
    s_add_u32 m0, s92, 27648
    s_add_u32 s59, s100, 387072
    buffer_load_dwordx4 v5, s[20:23], s59 offen lds
    ds_read_b64_tr_b16 v[96:97], v12 offset:12288
    ds_read_b64_tr_b16 v[98:99], v12 offset:12544
    s_waitcnt lgkmcnt(4)
    v_mfma_f32_32x32x16_bf16 v[64:79], v[100:103], v[168:171], v[64:79]
    s_add_u32 m0, s92, 0
    s_add_u32 s59, s94, 0
    buffer_load_dwordx4 v4, s[16:19], s59 offen lds
    ds_read_b64_tr_b16 v[100:101], v13 offset:12288
    ds_read_b64_tr_b16 v[102:103], v13 offset:12544
    s_waitcnt lgkmcnt(4)
    v_mfma_f32_32x32x16_bf16 v[64:79], v[104:107], v[172:175], v[64:79]
    s_add_u32 m0, s92, 1024
    s_add_u32 s59, s94, 7168
    buffer_load_dwordx4 v4, s[16:19], s59 offen lds
    ds_read_b64_tr_b16 v[104:105], v14 offset:12288
    ds_read_b64_tr_b16 v[106:107], v14 offset:12544
    s_waitcnt lgkmcnt(4)
    v_mfma_f32_32x32x16_bf16 v[64:79], v[96:99], v[176:179], v[64:79]
    s_add_u32 m0, s92, 2048
    s_add_u32 s59, s94, 14336
    buffer_load_dwordx4 v4, s[16:19], s59 offen lds
    v_mfma_f32_4x4x4_16b_bf16 v[112:115], v[24:25], v[96:97], v[112:115]
    v_mfma_f32_4x4x4_16b_bf16 v[116:119], v[24:25], v[98:99], v[116:119]
    ds_read_b64_tr_b16 v[96:97], v15 offset:12288
    ds_read_b64_tr_b16 v[98:99], v15 offset:12544
    s_waitcnt lgkmcnt(4)
    v_mfma_f32_32x32x16_bf16 v[64:79], v[100:103], v[180:183], v[64:79]
    s_add_u32 m0, s92, 3072
    s_add_u32 s59, s94, 21504
    buffer_load_dwordx4 v4, s[16:19], s59 offen lds
    ds_read_b64_tr_b16 v[100:101], v12 offset:16384
    ds_read_b64_tr_b16 v[102:103], v12 offset:16640
    s_waitcnt lgkmcnt(4)
    v_mfma_f32_32x32x16_bf16 v[64:79], v[104:107], v[184:187], v[64:79]
    s_add_u32 m0, s92, 4096
    s_add_u32 s59, s94, 28672
    buffer_load_dwordx4 v4, s[16:19], s59 offen lds
    ds_read_b64_tr_b16 v[104:105], v13 offset:16384
    ds_read_b64_tr_b16 v[106:107], v13 offset:16640
    s_waitcnt lgkmcnt(4)
    v_mfma_f32_32x32x16_bf16 v[64:79], v[96:99], v[188:191], v[64:79]
    s_add_u32 m0, s92, 5120
    s_add_u32 s59, s94, 35840
    buffer_load_dwordx4 v4, s[16:19], s59 offen lds
    ds_read_b64_tr_b16 v[96:97], v14 offset:16384
    ds_read_b64_tr_b16 v[98:99], v14 offset:16640
    s_waitcnt lgkmcnt(4)
    v_mfma_f32_32x32x16_bf16 v[64:79], v[100:103], v[192:195], v[64:79]
    s_add_u32 m0, s92, 6144
    s_add_u32 s59, s94, 43008
    buffer_load_dwordx4 v4, s[16:19], s59 offen lds
    v_mfma_f32_4x4x4_16b_bf16 v[112:115], v[24:25], v[100:101], v[112:115]
    v_mfma_f32_4x4x4_16b_bf16 v[116:119], v[24:25], v[102:103], v[116:119]
    ds_read_b64_tr_b16 v[100:101], v15 offset:16384
    ds_read_b64_tr_b16 v[102:103], v15 offset:16640
    s_waitcnt lgkmcnt(4)
    v_mfma_f32_32x32x16_bf16 v[64:79], v[104:107], v[196:199], v[64:79]
    s_add_u32 m0, s92, 7168
    s_add_u32 s59, s94, 50176
    buffer_load_dwordx4 v4, s[16:19], s59 offen lds
    ds_read_b64_tr_b16 v[104:105], v12 offset:20480
    ds_read_b64_tr_b16 v[106:107], v12 offset:20736
    s_waitcnt lgkmcnt(4)
    v_mfma_f32_32x32x16_bf16 v[64:79], v[96:99], v[200:203], v[64:79]
    s_add_u32 m0, s92, 8192
    s_add_u32 s59, s94, 57344
    buffer_load_dwordx4 v4, s[16:19], s59 offen lds
    ds_read_b64_tr_b16 v[96:97], v13 offset:20480
    ds_read_b64_tr_b16 v[98:99], v13 offset:20736
    s_waitcnt lgkmcnt(4)
    v_mfma_f32_32x32x16_bf16 v[64:79], v[100:103], v[204:207], v[64:79]
    s_add_u32 m0, s92, 9216
    s_add_u32 s59, s94, 64512
    buffer_load_dwordx4 v4, s[16:19], s59 offen lds
    ds_read_b64_tr_b16 v[100:101], v14 offset:20480
    ds_read_b64_tr_b16 v[102:103], v14 offset:20736
    s_waitcnt lgkmcnt(4)
    v_mfma_f32_32x32x16_bf16 v[64:79], v[104:107], v[208:211], v[64:79]
    s_add_u32 m0, s92, 10240
    s_add_u32 s59, s94, 71680
    buffer_load_dwordx4 v4, s[16:19], s59 offen lds
    v_mfma_f32_4x4x4_16b_bf16 v[112:115], v[24:25], v[104:105], v[112:115]
    v_mfma_f32_4x4x4_16b_bf16 v[116:119], v[24:25], v[106:107], v[116:119]
    ds_read_b64_tr_b16 v[104:105], v15 offset:20480
    ds_read_b64_tr_b16 v[106:107], v15 offset:20736
    s_waitcnt lgkmcnt(4)
    v_mfma_f32_32x32x16_bf16 v[64:79], v[96:99], v[212:215], v[64:79]
    s_add_u32 m0, s92, 11264
    s_add_u32 s59, s94, 78848
    buffer_load_dwordx4 v4, s[16:19], s59 offen lds
    ds_read_b64_tr_b16 v[96:97], v12 offset:24576
    ds_read_b64_tr_b16 v[98:99], v12 offset:24832
    s_waitcnt lgkmcnt(4)
    v_mfma_f32_32x32x16_bf16 v[64:79], v[100:103], v[216:219], v[64:79]
    s_add_u32 m0, s92, 12288
    s_add_u32 s59, s94, 86016
    buffer_load_dwordx4 v4, s[16:19], s59 offen lds
    ds_read_b64_tr_b16 v[100:101], v13 offset:24576
    ds_read_b64_tr_b16 v[102:103], v13 offset:24832
    s_waitcnt lgkmcnt(4)
    v_mfma_f32_32x32x16_bf16 v[64:79], v[104:107], v[220:223], v[64:79]
    s_add_u32 m0, s92, 13312
    s_add_u32 s59, s94, 93184
    buffer_load_dwordx4 v4, s[16:19], s59 offen lds
    ds_read_b64_tr_b16 v[104:105], v14 offset:24576
    ds_read_b64_tr_b16 v[106:107], v14 offset:24832
    s_waitcnt lgkmcnt(4)
    v_mfma_f32_32x32x16_bf16 v[64:79], v[96:99], v[224:227], v[64:79]
    v_mfma_f32_4x4x4_16b_bf16 v[112:115], v[24:25], v[96:97], v[112:115]
    v_mfma_f32_4x4x4_16b_bf16 v[116:119], v[24:25], v[98:99], v[116:119]
    s_nop 4
    v_add_f32 v52, v112, v116
    v_mov_b32 v53, v52
    ds_read_b64_tr_b16 v[96:97], v15 offset:24576
    ds_read_b64_tr_b16 v[98:99], v15 offset:24832
    s_waitcnt lgkmcnt(4)
    v_mfma_f32_32x32x16_bf16 v[64:79], v[100:103], v[228:231], v[64:79]
    v_permlane32_swap_b32 v52, v53
    v_add_f32 v52, v52, v53
    ds_write_b32 v55, v52 offset:2048
    s_waitcnt lgkmcnt(0)
    s_barrier
    s_waitcnt lgkmcnt(3)
    v_mfma_f32_32x32x16_bf16 v[64:79], v[104:107], v[232:235], v[64:79]
    ds_read_b128 v[56:59], v62 offset:2048
    s_waitcnt lgkmcnt(2)
    v_mfma_f32_32x32x16_bf16 v[64:79], v[96:99], v[236:239], v[64:79]
    s_waitcnt lgkmcnt(0)
    v_add_f32 v56, v56, v57
    v_add_f32 v58, v58, v59
    v_add_f32 v60, v56, v58
    v_cndmask_b32 v52, v60, 0, s[72:73]
    v_cvt_pk_bf16_f32 v46, v52, v52
    v_lshlrev_b32 v53, 16, v46
    v_sub_f32 v53, v52, v53
    v_cvt_pk_bf16_f32 v47, v53, 0
    s_nop 1
    v_mfma_f32_32x32x16_bf16 v[64:79], v[46:49], v[42:45], v[64:79]
    s_nop 11
    v_cndmask_b32 v76, v76, 0, s[72:73]
    v_cndmask_b32 v77, v77, 0, s[72:73]
    v_cndmask_b32 v78, v78, 0, s[72:73]
    v_cndmask_b32 v79, v79, 0, s[72:73]
    v_cvt_pk_bf16_f32 v80, v64, v65
    v_cvt_pk_bf16_f32 v81, v66, v67
    v_cvt_pk_bf16_f32 v82, v68, v69
    v_cvt_pk_bf16_f32 v83, v70, v71
    v_cvt_pk_bf16_f32 v84, v72, v73
    v_cvt_pk_bf16_f32 v85, v74, v75
    v_cvt_pk_bf16_f32 v86, v76, v77
    v_cvt_pk_bf16_f32 v87, v78, v79
    v_mfma_f32_32x32x16_bf16 v[96:111], v[26:29], v[80:83], 0
    s_nop 0
    v_mfma_f32_32x32x16_bf16 v[96:111], v[30:33], v[84:87], v[96:111]
    s_nop 11
    v_cndmask_b32 v108, v108, v96, s[72:73]
    v_cndmask_b32 v109, v109, v96, s[72:73]
    v_cndmask_b32 v110, v110, v96, s[72:73]
    v_cndmask_b32 v111, v111, v96, s[72:73]
    v_max3_f32 v52, v96, v97, v98
    v_min3_f32 v53, v96, v97, v98
    v_max3_f32 v52, v52, v99, v100
    v_min3_f32 v53, v53, v99, v100
    v_max3_f32 v52, v52, v101, v102
    v_min3_f32 v53, v53, v101, v102
    v_max3_f32 v52, v52, v103, v104
    v_min3_f32 v53, v53, v103, v104
    v_max3_f32 v52, v52, v105, v106
    v_min3_f32 v53, v53, v105, v106
    v_max3_f32 v52, v52, v107, v108
    v_min3_f32 v53, v53, v107, v108
    v_max3_f32 v52, v52, v109, v110
    v_min3_f32 v53, v53, v109, v110
    v_max_f32 v52, v52, v111
    v_min_f32 v53, v53, v111
    v_sub_f32 v53, 0, v53
    s_nop 1
    v_permlane32_swap_b32 v52, v53
    v_max_f32 v52, v52, v53
    v_mov_b32 v53, v52
    s_nop 1
    v_permlane32_swap_b32 v52, v53
    v_mul_f32 v56, v51, v52
    v_mul_f32 v58, v51, v53
    v_mov_b32 v54, v51
    v_pk_fma_f32 v[112:113], v[96:97], v[54:55], v[56:57] op_sel_hi:[1,0,0] neg_lo:[0,0,1] neg_hi:[0,0,1]
    v_pk_fma_f32 v[114:115], v[98:99], v[54:55], v[56:57] op_sel_hi:[1,0,0] neg_lo:[0,0,1] neg_hi:[0,0,1]
    v_pk_fma_f32 v[116:117], v[100:101], v[54:55], v[56:57] op_sel_hi:[1,0,0] neg_lo:[0,0,1] neg_hi:[0,0,1]
    v_pk_fma_f32 v[118:119], v[102:103], v[54:55], v[56:57] op_sel_hi:[1,0,0] neg_lo:[0,0,1] neg_hi:[0,0,1]
    v_pk_fma_f32 v[120:121], v[104:105], v[54:55], v[56:57] op_sel_hi:[1,0,0] neg_lo:[0,0,1] neg_hi:[0,0,1]
    v_pk_fma_f32 v[122:123], v[106:107], v[54:55], v[56:57] op_sel_hi:[1,0,0] neg_lo:[0,0,1] neg_hi:[0,0,1]
    v_pk_fma_f32 v[124:125], v[108:109], v[54:55], v[56:57] op_sel_hi:[1,0,0] neg_lo:[0,0,1] neg_hi:[0,0,1]
    v_pk_fma_f32 v[126:127], v[110:111], v[54:55], v[56:57] op_sel_hi:[1,0,0] neg_lo:[0,0,1] neg_hi:[0,0,1]
    v_pk_fma_f32 v[64:65], v[96:97], v[54:55], v[58:59] op_sel_hi:[1,0,0] neg_lo:[0,1,1] neg_hi:[0,1,1]
    v_pk_fma_f32 v[66:67], v[98:99], v[54:55], v[58:59] op_sel_hi:[1,0,0] neg_lo:[0,1,1] neg_hi:[0,1,1]
    v_pk_fma_f32 v[68:69], v[100:101], v[54:55], v[58:59] op_sel_hi:[1,0,0] neg_lo:[0,1,1] neg_hi:[0,1,1]
    v_pk_fma_f32 v[70:71], v[102:103], v[54:55], v[58:59] op_sel_hi:[1,0,0] neg_lo:[0,1,1] neg_hi:[0,1,1]
    v_pk_fma_f32 v[72:73], v[104:105], v[54:55], v[58:59] op_sel_hi:[1,0,0] neg_lo:[0,1,1] neg_hi:[0,1,1]
    v_pk_fma_f32 v[74:75], v[106:107], v[54:55], v[58:59] op_sel_hi:[1,0,0] neg_lo:[0,1,1] neg_hi:[0,1,1]
    v_pk_fma_f32 v[76:77], v[108:109], v[54:55], v[58:59] op_sel_hi:[1,0,0] neg_lo:[0,1,1] neg_hi:[0,1,1]
    v_pk_fma_f32 v[78:79], v[110:111], v[54:55], v[58:59] op_sel_hi:[1,0,0] neg_lo:[0,1,1] neg_hi:[0,1,1]
    v_exp_f32 v112, v112
    v_exp_f32 v113, v113
    v_exp_f32 v114, v114
    v_exp_f32 v115, v115
    v_exp_f32 v116, v116
    v_exp_f32 v117, v117
    v_exp_f32 v118, v118
    v_exp_f32 v119, v119
    v_exp_f32 v120, v120
    v_exp_f32 v121, v121
    v_exp_f32 v122, v122
    v_exp_f32 v123, v123
    v_exp_f32 v124, v124
    v_exp_f32 v125, v125
    v_exp_f32 v126, v126
    v_exp_f32 v127, v127
    v_cndmask_b32 v124, v124, 0, s[72:73]
    v_cndmask_b32 v125, v125, 0, s[72:73]
    v_cndmask_b32 v126, v126, 0, s[72:73]
    v_cndmask_b32 v127, v127, 0, s[72:73]
    v_pk_add_f32 v[96:97], v[112:113], v[114:115]
    v_pk_add_f32 v[98:99], v[116:117], v[118:119]
    v_pk_add_f32 v[100:101], v[120:121], v[122:123]
    v_pk_add_f32 v[102:103], v[124:125], v[126:127]
    v_pk_add_f32 v[96:97], v[96:97], v[98:99]
    v_pk_add_f32 v[100:101], v[100:101], v[102:103]
    v_pk_add_f32 v[96:97], v[96:97], v[100:101]
    v_add_f32 v96, v96, v97
    v_mov_b32 v97, v96
    s_nop 1
    v_permlane32_swap_b32 v96, v97
    v_add_f32 v96, v96, v97
    v_rcp_f32 v96, v96
    s_nop 0
    v_pk_mul_f32 v[112:113], v[112:113], v[96:97] op_sel_hi:[1,0]
    v_pk_mul_f32 v[114:115], v[114:115], v[96:97] op_sel_hi:[1,0]
    v_pk_mul_f32 v[116:117], v[116:117], v[96:97] op_sel_hi:[1,0]
    v_pk_mul_f32 v[118:119], v[118:119], v[96:97] op_sel_hi:[1,0]
    v_pk_mul_f32 v[120:121], v[120:121], v[96:97] op_sel_hi:[1,0]
    v_pk_mul_f32 v[122:123], v[122:123], v[96:97] op_sel_hi:[1,0]
    v_pk_mul_f32 v[124:125], v[124:125], v[96:97] op_sel_hi:[1,0]
    v_pk_mul_f32 v[126:127], v[126:127], v[96:97] op_sel_hi:[1,0]
    v_cvt_pk_bf16_f32 v240, v112, v113
    v_cvt_pk_bf16_f32 v241, v114, v115
    v_cvt_pk_bf16_f32 v242, v116, v117
    v_cvt_pk_bf16_f32 v243, v118, v119
    v_cvt_pk_bf16_f32 v244, v120, v121
    v_cvt_pk_bf16_f32 v245, v122, v123
    v_cvt_pk_bf16_f32 v246, v124, v125
    v_cvt_pk_bf16_f32 v247, v126, v127
    v_exp_f32 v64, v64
    v_exp_f32 v65, v65
    v_exp_f32 v66, v66
    v_exp_f32 v67, v67
    v_exp_f32 v68, v68
    v_exp_f32 v69, v69
    v_exp_f32 v70, v70
    v_exp_f32 v71, v71
    v_exp_f32 v72, v72
    v_exp_f32 v73, v73
    v_exp_f32 v74, v74
    v_exp_f32 v75, v75
    v_exp_f32 v76, v76
    v_exp_f32 v77, v77
    v_exp_f32 v78, v78
    v_exp_f32 v79, v79
    v_cndmask_b32 v76, v76, 0, s[72:73]
    v_cndmask_b32 v77, v77, 0, s[72:73]
    v_cndmask_b32 v78, v78, 0, s[72:73]
    v_cndmask_b32 v79, v79, 0, s[72:73]
    v_pk_add_f32 v[96:97], v[64:65], v[66:67]
    v_pk_add_f32 v[98:99], v[68:69], v[70:71]
    v_pk_add_f32 v[100:101], v[72:73], v[74:75]
    v_pk_add_f32 v[102:103], v[76:77], v[78:79]
    v_pk_add_f32 v[96:97], v[96:97], v[98:99]
    v_pk_add_f32 v[100:101], v[100:101], v[102:103]
    v_pk_add_f32 v[96:97], v[96:97], v[100:101]
    v_add_f32 v96, v96, v97
    v_mov_b32 v97, v96
    s_nop 1
    v_permlane32_swap_b32 v96, v97
    v_add_f32 v96, v96, v97
    v_rcp_f32 v96, v96
    s_nop 0
    v_pk_mul_f32 v[64:65], v[64:65], v[96:97] op_sel_hi:[1,0]
    v_pk_mul_f32 v[66:67], v[66:67], v[96:97] op_sel_hi:[1,0]
    v_pk_mul_f32 v[68:69], v[68:69], v[96:97] op_sel_hi:[1,0]
    v_pk_mul_f32 v[70:71], v[70:71], v[96:97] op_sel_hi:[1,0]
    v_pk_mul_f32 v[72:73], v[72:73], v[96:97] op_sel_hi:[1,0]
    v_pk_mul_f32 v[74:75], v[74:75], v[96:97] op_sel_hi:[1,0]
    v_pk_mul_f32 v[76:77], v[76:77], v[96:97] op_sel_hi:[1,0]
    v_pk_mul_f32 v[78:79], v[78:79], v[96:97] op_sel_hi:[1,0]
    v_cvt_pk_bf16_f32 v248, v64, v65
    v_cvt_pk_bf16_f32 v249, v66, v67
    v_cvt_pk_bf16_f32 v250, v68, v69
    v_cvt_pk_bf16_f32 v251, v70, v71
    v_cvt_pk_bf16_f32 v252, v72, v73
    v_cvt_pk_bf16_f32 v253, v74, v75
    v_cvt_pk_bf16_f32 v254, v76, v77
    v_cvt_pk_bf16_f32 v255, v78, v79
    s_waitcnt vmcnt(24)
    v_cmp_eq_u32 vcc, s49, v88
    s_nop 1
    s_cmp_eq_u64 vcc, -1
    s_cbranch_scc1 Lxok_1
    s_mov_b32 s58, 0
    s_lshl_b32 s55, s44, 8
    s_add_u32 s55, s55, 1024
    v_lshlrev_b32 v52, 3, v2
Lxs_2:
    buffer_load_dwordx2 v[88:89], v52, s[40:43], s55 offen sc1
    s_waitcnt vmcnt(0)
    v_cmp_eq_u32 vcc, s49, v88
    s_nop 1
    s_cmp_eq_u64 vcc, -1
    s_cbranch_scc1 Lxok_1
    s_add_u32 s58, s58, 1
    s_cmp_lt_u32 s58, 0x40000
    s_cbranch_scc1 Lxs_2
Lxok_1:
    v_readfirstlane_b32 s55, v89
    s_nop 1
    v_cmp_eq_u32 vcc, s55, v89
    s_nop 1
    s_cmp_eq_u64 vcc, -1
    s_cselect_b32 s50, 1, 0
    v_accvgpr_read_b32 v52, a146
    s_lshl_b32 s53, s46, 6
    s_add_u32 s53, s53, s47
    s_lshl_b32 s53, s53, 10
    s_add_u32 s82, s53, 1048576
    v_accvgpr_read_b32 v12, a134
    v_accvgpr_read_b32 v13, a135
    v_accvgpr_read_b32 v14, a136
    v_accvgpr_read_b32 v15, a137
    v_and_b32 v58, 15, v1
    v_lshrrev_b32 v58, 2, v58
    v_bfe_u32 v59, v1, 4, 1
    v_and_b32 v60, 3, v1
    s_lshl_b32 s56, s44, 3
    s_lshl_b32 s53, s64, 1
    s_add_u32 s56, s56, s53
    v_bfe_u32 v53, v1, 2, 1
    v_lshlrev_b32 v53, 6, v53
    v_lshl_add_u32 v53, v60, 2, v53
    s_lshl_b32 s53, s56, 4
    s_lshl_b32 s54, s47, 2
    s_add_u32 s53, s53, s54
    s_lshl_b32 s53, s53, 2
    s_add_u32 s53, s53, 8192
    v_add_u32 v52, s53, v53
    v_accvgpr_write_b32 a148, v52
    s_mul_i32 s54, s47, 28
    s_lshr_b32 s54, s54, 3
    s_lshl_b32 s53, s56, 4
    s_add_u32 s53, s53, s54
    s_lshl_b32 s53, s53, 2
    s_add_u32 s53, s53, 16384
    v_add_u32 v52, s53, v53
    v_accvgpr_write_b32 a154, v52
    s_lshr_b32 s57, s47, 1
    s_add_u32 s57, s57, s56
    s_and_b32 s54, s47, 1
    s_lshl_b32 s53, s65, 1
    s_add_u32 s54, s54, s53
    s_lshl_b32 s57, s57, 4
    s_add_u32 s57, s57, s54
    s_lshl_b32 s57, s57, 2
    s_add_u32 s57, s57, 12288
    v_mov_b32 v52, 0x80000000
    v_writelane_b32 v52, s57, 0
    v_accvgpr_write_b32 a149, v52
    v_lshlrev_b32 v52, 3, v2
    v_mov_b32 v53, 0x80000000
    v_cndmask_b32 v52, v52, v53, s[72:73]
    v_accvgpr_write_b32 a150, v52
    s_lshl_b32 s56, s44, 3
    s_lshl_b32 s53, s66, 2
    s_add_u32 s56, s56, s53
    s_add_u32 s56, s56, s47
    s_lshl_b32 s53, s56, 6
    s_add_u32 s53, s53, 12288
    v_and_b32 v52, 15, v1
    v_min_u32 v52, 13, v52
    v_lshlrev_b32 v52, 2, v52
    v_add_u32 v52, s53, v52
    v_accvgpr_write_b32 a151, v52
    v_mul_u32_u24 v52, 1792, v3
    v_lshl_add_u32 v52, v2, 3, v52
    v_accvgpr_write_b32 a152, v52
    s_lshl_b32 s54, s56, 4
    s_add_u32 s54, s54, s67
    s_lshl_b32 s54, s54, 2
    s_add_u32 s54, s54, 16384
    v_mov_b32 v52, 0x80000000
    v_writelane_b32 v52, s54, 0
    v_accvgpr_write_b32 a153, v52
    v_mul_u32_u24 v52, 896, v2
    v_lshl_add_u32 v6, v3, 4, v52
    s_xor_b32 s53, s47, 1
    s_mul_i32 s53, s53, 3
    s_add_u32 s53, s53, 0
    s_lshl_b32 s54, s53, 12
    s_cmp_lt_u32 s53, 10
    s_cselect_b32 s58, 0, 163840
    s_add_u32 s54, s54, 122880
    s_sub_u32 s54, s54, s58
    v_add_u32 v52, s54, v62
    v_accvgpr_write_b32 a155, v52
    s_mul_i32 s53, s47, 3
    s_add_u32 s53, s53, 0
    s_lshl_b32 s54, s53, 12
    s_cmp_lt_u32 s53, 10
    s_cselect_b32 s58, 0, 163840
    s_add_u32 s54, s54, 122880
    s_sub_u32 s54, s54, s58
    v_add_u32 v52, s54, v62
    v_accvgpr_write_b32 a158, v52
    s_xor_b32 s53, s47, 2
    s_mul_i32 s53, s53, 3
    s_add_u32 s53, s53, 1
    s_lshl_b32 s54, s53, 12
    s_cmp_lt_u32 s53, 10
    s_cselect_b32 s58, 0, 163840
    s_add_u32 s54, s54, 122880
    s_sub_u32 s54, s54, s58
    v_add_u32 v52, s54, v62
    v_accvgpr_write_b32 a156, v52
    s_mul_i32 s53, s47, 3
    s_add_u32 s53, s53, 1
    s_lshl_b32 s54, s53, 12
    s_cmp_lt_u32 s53, 10
    s_cselect_b32 s58, 0, 163840
    s_add_u32 s54, s54, 122880
    s_sub_u32 s54, s54, s58
    v_add_u32 v52, s54, v62
    v_accvgpr_write_b32 a159, v52
    s_xor_b32 s53, s47, 3
    s_mul_i32 s53, s53, 3
    s_add_u32 s53, s53, 2
    s_lshl_b32 s54, s53, 12
    s_cmp_lt_u32 s53, 10
    s_cselect_b32 s58, 0, 163840
    s_add_u32 s54, s54, 122880
    s_sub_u32 s54, s54, s58
    v_add_u32 v52, s54, v62
    v_accvgpr_write_b32 a157, v52
    s_mul_i32 s53, s47, 3
    s_add_u32 s53, s53, 2
    s_lshl_b32 s54, s53, 12
    s_cmp_lt_u32 s53, 10
    s_cselect_b32 s58, 0, 163840
    s_add_u32 s54, s54, 122880
    s_sub_u32 s54, s54, s58
    v_add_u32 v52, s54, v62
    v_accvgpr_write_b32 a160, v52
    s_lshl_b32 s53, s44, 8
    s_lshl_b32 s54, s64, 6
    s_add_u32 s53, s53, s54
    s_lshr_b32 s54, s47, 1
    s_lshl_b32 s54, s54, 5
    s_add_u32 s53, s53, s54
    s_mul_i32 s53, s53, 896
    s_lshl_b32 s54, s65, 7
    s_add_u32 s53, s53, s54
    s_and_b32 s54, s47, 1
    s_lshl_b32 s54, s54, 6
    s_add_u32 s69, s53, s54
    v_accvgpr_read_b32 v52, a146
    s_mov_b32 s58, 0
Lpoll_3:
    buffer_load_dword v53, v52, s[40:43], 0 offen sc1
    s_waitcnt vmcnt(0)
    v_cmp_eq_u32 vcc, s49, v53
    s_nop 1
    s_cmp_eq_u64 vcc, -1
    s_cbranch_scc1 Lpd_4
    s_add_u32 s58, s58, 1
    s_cmp_lt_u32 s58, 0x40000
    s_cbranch_scc1 Lpoll_3
Lpd_4:
    s_add_u32 s54, s82, 0
    buffer_load_dwordx4 v[64:67], v62, s[40:43], s54 offen
    s_add_u32 s54, s82, 4096
    buffer_load_dwordx4 v[68:71], v62, s[40:43], s54 offen
    s_add_u32 s54, s82, 8192
    buffer_load_dwordx4 v[72:75], v62, s[40:43], s54 offen
    s_add_u32 s54, s82, 12288
    buffer_load_dwordx4 v[76:79], v62, s[40:43], s54 offen
    s_add_u32 s54, s82, 16384
    buffer_load_dwordx4 v[80:83], v62, s[40:43], s54 offen
    s_add_u32 s54, s82, 20480
    buffer_load_dwordx4 v[84:87], v62, s[40:43], s54 offen
    s_add_u32 s54, s82, 24576
    buffer_load_dwordx4 v[88:91], v62, s[40:43], s54 offen
    s_add_u32 s54, s82, 28672
    buffer_load_dwordx4 v[92:95], v62, s[40:43], s54 offen
    s_add_u32 s54, s82, 32768
    buffer_load_dwordx4 v[96:99], v62, s[40:43], s54 offen
    s_add_u32 s54, s82, 36864
    buffer_load_dwordx4 v[100:103], v62, s[40:43], s54 offen
    s_add_u32 s54, s82, 40960
    buffer_load_dwordx4 v[104:107], v62, s[40:43], s54 offen
    s_add_u32 s54, s82, 45056
    buffer_load_dwordx4 v[108:111], v62, s[40:43], s54 offen
    s_add_u32 s54, s82, 49152
    buffer_load_dwordx4 v[112:115], v62, s[40:43], s54 offen
    s_add_u32 s54, s82, 53248
    buffer_load_dwordx4 v[116:119], v62, s[40:43], s54 offen
    s_add_u32 s54, s82, 57344
    buffer_load_dwordx4 v[120:123], v62, s[40:43], s54 offen
    s_add_u32 s54, s82, 61440
    buffer_load_dwordx4 v[124:127], v62, s[40:43], s54 offen
    v_lshlrev_b32 v228, 9, v3
    v_sub_u32 v229, v9, v228
    v_sub_u32 v228, v8, v228
    ds_read_b64_tr_b16 a[0:1], v8 offset:0
    ds_read_b64_tr_b16 a[2:3], v8 offset:1024
    ds_read_b64_tr_b16 a[4:5], v9 offset:0
    ds_read_b64_tr_b16 a[6:7], v9 offset:1024
    ds_read_b64_tr_b16 a[8:9], v8 offset:2048
    ds_read_b64_tr_b16 a[10:11], v8 offset:3072
    ds_read_b64_tr_b16 a[12:13], v9 offset:2048
    ds_read_b64_tr_b16 a[14:15], v9 offset:3072
    ds_read_b64_tr_b16 a[16:17], v8 offset:3584
    ds_read_b64_tr_b16 a[18:19], v8 offset:4608
    ds_read_b64_tr_b16 a[20:21], v9 offset:3584
    ds_read_b64_tr_b16 a[22:23], v9 offset:4608
    ds_read_b64_tr_b16 a[24:25], v8 offset:5632
    ds_read_b64_tr_b16 a[26:27], v8 offset:6656
    ds_read_b64_tr_b16 a[28:29], v9 offset:5632
    ds_read_b64_tr_b16 a[30:31], v9 offset:6656
    ds_read_b64_tr_b16 a[32:33], v8 offset:7168
    ds_read_b64_tr_b16 a[34:35], v8 offset:8192
    ds_read_b64_tr_b16 a[36:37], v9 offset:7168
    ds_read_b64_tr_b16 a[38:39], v9 offset:8192
    ds_read_b64_tr_b16 a[40:41], v8 offset:9216
    ds_read_b64_tr_b16 a[42:43], v8 offset:10240
    ds_read_b64_tr_b16 a[44:45], v9 offset:9216
    ds_read_b64_tr_b16 a[46:47], v9 offset:10240
    ds_read_b64_tr_b16 a[48:49], v8 offset:10752
    ds_read_b64_tr_b16 a[50:51], v8 offset:11776
    ds_read_b64_tr_b16 a[52:53], v9 offset:10752
    ds_read_b64_tr_b16 a[54:55], v9 offset:11776
    ds_read_b64_tr_b16 a[56:57], v8 offset:12800
    ds_read_b64_tr_b16 a[58:59], v228 offset:13824
    ds_read_b64_tr_b16 a[60:61], v9 offset:12800
    ds_read_b64_tr_b16 a[62:63], v229 offset:13824
    s_waitcnt lgkmcnt(0)
    s_add_u32 m0, s92, 0
    s_add_u32 s59, s100, 0
    buffer_load_dwordx4 v5, s[20:23], s59 offen lds
    s_add_u32 m0, s92, 1024
    s_add_u32 s59, s100, 14336
    buffer_load_dwordx4 v5, s[20:23], s59 offen lds
    s_add_u32 m0, s92, 2048
    s_add_u32 s59, s100, 28672
    buffer_load_dwordx4 v5, s[20:23], s59 offen lds
    s_add_u32 m0, s92, 3072
    s_add_u32 s59, s100, 43008
    buffer_load_dwordx4 v5, s[20:23], s59 offen lds
    s_add_u32 m0, s92, 4096
    s_add_u32 s59, s100, 57344
    buffer_load_dwordx4 v5, s[20:23], s59 offen lds
    s_add_u32 m0, s92, 5120
    s_add_u32 s59, s100, 71680
    buffer_load_dwordx4 v5, s[20:23], s59 offen lds
    v_accvgpr_read_b32 v52, a163
    v_accvgpr_read_b32 v54, a147
    v_mov_b32 v61, s49
    s_waitcnt vmcnt(21)
    v_mfma_f32_32x32x16_bf16 v[212:227], a[176:179], v[64:67], 0
    s_add_u32 m0, s92, 6144
    s_add_u32 s59, s100, 86016
    buffer_load_dwordx4 v5, s[20:23], s59 offen lds
    s_waitcnt vmcnt(21)
    v_mfma_f32_32x32x16_bf16 v[212:227], a[176:179], v[68:71], v[212:227]
    s_add_u32 m0, s92, 7168
    s_add_u32 s59, s100, 100352
    buffer_load_dwordx4 v5, s[20:23], s59 offen lds
    s_waitcnt vmcnt(21)
    v_mfma_f32_32x32x16_bf16 v[212:227], a[176:179], v[72:75], v[212:227]
    s_add_u32 m0, s92, 8192
    s_add_u32 s59, s100, 114688
    buffer_load_dwordx4 v5, s[20:23], s59 offen lds
    s_waitcnt vmcnt(21)
    v_mfma_f32_32x32x16_bf16 v[212:227], a[176:179], v[76:79], v[212:227]
    s_add_u32 m0, s92, 9216
    s_add_u32 s59, s100, 129024
    buffer_load_dwordx4 v5, s[20:23], s59 offen lds
    s_waitcnt vmcnt(21)
    v_mfma_f32_32x32x16_bf16 v[212:227], a[176:179], v[80:83], v[212:227]
    s_add_u32 m0, s92, 10240
    s_add_u32 s59, s100, 143360
    buffer_load_dwordx4 v5, s[20:23], s59 offen lds
    s_waitcnt vmcnt(21)
    v_mfma_f32_32x32x16_bf16 v[212:227], a[176:179], v[84:87], v[212:227]
    s_add_u32 m0, s92, 11264
    s_add_u32 s59, s100, 157696
    buffer_load_dwordx4 v5, s[20:23], s59 offen lds
    s_waitcnt vmcnt(21)
    v_mfma_f32_32x32x16_bf16 v[212:227], a[176:179], v[88:91], v[212:227]
    s_add_u32 m0, s92, 12288
    s_add_u32 s59, s100, 172032
    buffer_load_dwordx4 v5, s[20:23], s59 offen lds
    s_waitcnt vmcnt(21)
    v_mfma_f32_32x32x16_bf16 v[212:227], a[176:179], v[92:95], v[212:227]
    s_add_u32 m0, s92, 13312
    s_add_u32 s59, s100, 186368
    buffer_load_dwordx4 v5, s[20:23], s59 offen lds
    s_waitcnt vmcnt(21)
    v_mfma_f32_32x32x16_bf16 v[212:227], a[176:179], v[96:99], v[212:227]
    buffer_load_dwordx4 v[34:37], v6, s[4:7], s69 offen
    buffer_load_dwordx4 v[38:41], v6, s[4:7], s69 offen offset:32
    s_lshl_b32 s53, s67, 8
    s_lshl_b32 s54, s47, 6
    s_add_u32 s53, s53, s54
    v_lshlrev_b32 v55, 1, v2
    buffer_load_ushort v7, v55, s[24:27], s53 offen
    s_lshl_b32 s53, s65, 7
    s_and_b32 s54, s47, 1
    s_lshl_b32 s54, s54, 6
    s_add_u32 s53, s53, s54
    buffer_load_ushort v42, v55, s[32:35], s53 offen
    s_lshl_b32 s57, s44, 3
    s_lshl_b32 s53, s64, 1
    s_add_u32 s57, s57, s53
    s_lshr_b32 s54, s47, 1
    s_add_u32 s57, s57, s54
    s_and_b32 s54, s47, 1
    s_lshl_b32 s53, s65, 1
    s_add_u32 s54, s54, s53
    s_mul_i32 s53, s57, 28
    s_lshl_b32 s55, s54, 1
    s_add_u32 s53, s53, s55
    s_lshl_b32 s53, s53, 10
    s_add_u32 s85, s53, 4194304
    v_lshlrev_b32 v55, 7, v1
    v_cmp_gt_u32 vcc, 16, v1
    v_mov_b32 v56, 0x80000000
    s_nop 0
    v_cndmask_b32 v55, v56, v55, vcc
    buffer_load_dword a254, v55, s[40:43], s85 offen
    s_mul_i32 s55, s57, 14
    s_add_u32 s55, s55, s54
    s_lshl_b32 s55, s55, 8
    s_add_u32 s101, s55, 6291456
    v_lshlrev_b32 v55, 7, v1
    v_cmp_gt_u32 vcc, 2, v1
    v_mov_b32 v56, 0x80000000
    s_nop 0
    v_cndmask_b32 v55, v56, v55, vcc
    buffer_load_dword a253, v55, s[40:43], s101 offen
    s_waitcnt vmcnt(26)
    v_mfma_f32_32x32x16_bf16 v[212:227], a[176:179], v[100:103], v[212:227]
    s_waitcnt vmcnt(25)
    v_mfma_f32_32x32x16_bf16 v[212:227], a[176:179], v[104:107], v[212:227]
    s_waitcnt vmcnt(24)
    v_mfma_f32_32x32x16_bf16 v[212:227], a[176:179], v[108:111], v[212:227]
    s_waitcnt vmcnt(23)
    v_mfma_f32_32x32x16_bf16 v[212:227], a[176:179], v[112:115], v[212:227]
    s_waitcnt vmcnt(22)
    v_mfma_f32_32x32x16_bf16 v[212:227], a[176:179], v[116:119], v[212:227]
    s_waitcnt vmcnt(21)
    v_mfma_f32_32x32x16_bf16 v[212:227], a[176:179], v[120:123], v[212:227]
    s_waitcnt vmcnt(20)
    v_mfma_f32_32x32x16_bf16 v[212:227], a[176:179], v[124:127], v[212:227]
    s_nop 11
    v_cvt_pk_bf16_f32 v64, v212, v213
    v_cvt_pk_bf16_f32 v65, v214, v215
    v_cvt_pk_bf16_f32 v66, v216, v217
    v_cvt_pk_bf16_f32 v67, v218, v219
    ds_write_b128 v52, v[64:67] offset:4096
    s_waitcnt lgkmcnt(0)
    s_barrier
    ds_read_b128 v[68:71], v62 offset:4096
    ds_read_b128 v[72:75], v62 offset:5120
    ds_read_b128 v[76:79], v62 offset:6144
    ds_read_b128 v[80:83], v62 offset:7168
    s_waitcnt lgkmcnt(3)
    v_mfma_f32_32x32x16_bf16 v[96:111], v[68:71], v[240:243], 0
    s_waitcnt lgkmcnt(2)
    v_mfma_f32_32x32x16_bf16 v[96:111], v[72:75], v[244:247], v[96:111]
    s_waitcnt lgkmcnt(1)
    v_mfma_f32_32x32x16_bf16 v[96:111], v[76:79], v[248:251], v[96:111]
    s_waitcnt lgkmcnt(0)
    v_mfma_f32_32x32x16_bf16 v[96:111], v[80:83], v[252:255], v[96:111]
    s_nop 11
    v_mov_b32 v56, v108
    v_mov_b32 v57, v108
    s_nop 1
    v_permlane32_swap_b32 v56, v57
    v_add_f32 v57, 0x358637bd, v57
    v_cndmask_b32 v108, v108, 0, s[72:73]
    v_cndmask_b32 v109, v109, 0, s[72:73]
    v_cndmask_b32 v110, v110, 0, s[72:73]
    v_cndmask_b32 v111, v111, 0, s[72:73]
    v_rcp_f32 v56, v57
    s_nop 0
    v_pk_mul_f32 v[96:97], v[96:97], v[56:57] op_sel_hi:[1,0]
    v_pk_mul_f32 v[98:99], v[98:99], v[56:57] op_sel_hi:[1,0]
    v_pk_mul_f32 v[100:101], v[100:101], v[56:57] op_sel_hi:[1,0]
    v_pk_mul_f32 v[102:103], v[102:103], v[56:57] op_sel_hi:[1,0]
    v_pk_mul_f32 v[104:105], v[104:105], v[56:57] op_sel_hi:[1,0]
    v_pk_mul_f32 v[106:107], v[106:107], v[56:57] op_sel_hi:[1,0]
    v_pk_mul_f32 v[108:109], v[108:109], v[56:57] op_sel_hi:[1,0]
    v_pk_mul_f32 v[110:111], v[110:111], v[56:57] op_sel_hi:[1,0]
    v_cvt_pk_bf16_f32 v64, v96, v97
    v_cvt_pk_bf16_f32 v65, v98, v99
    v_cvt_pk_bf16_f32 v66, v100, v101
    v_cvt_pk_bf16_f32 v67, v102, v103
    v_cvt_pk_bf16_f32 v68, v104, v105
    v_cvt_pk_bf16_f32 v69, v106, v107
    v_cvt_pk_bf16_f32 v70, v108, v109
    v_cvt_pk_bf16_f32 v71, v110, v111
    s_cmp_eq_u32 s50, 1
    s_cbranch_scc0 Lfb_5
    buffer_store_dwordx4 v[64:67], v62, s[40:43], s84 offen
    buffer_store_dwordx4 v[68:71], v62, s[40:43], s84 offen offset:1024
    s_branch Ldn_6
Lfb_5:
    buffer_store_dwordx4 v[64:67], v62, s[40:43], s84 offen sc1
    buffer_store_dwordx4 v[68:71], v62, s[40:43], s84 offen offset:1024 sc1
Ldn_6:
    s_waitcnt vmcnt(4)
    v_permlane32_swap_b32 v34, v36
    v_permlane32_swap_b32 v35, v37
    v_permlane32_swap_b32 v38, v40
    v_permlane32_swap_b32 v39, v41
    v_lshlrev_b32 v208, 16, v34
    v_and_b32 v209, 0xffff0000, v34
    v_lshlrev_b32 v210, 16, v35
    v_and_b32 v211, 0xffff0000, v35
    v_lshlrev_b32 v212, 16, v36
    v_and_b32 v213, 0xffff0000, v36
    v_lshlrev_b32 v214, 16, v37
    v_and_b32 v215, 0xffff0000, v37
    v_lshlrev_b32 v216, 16, v38
    v_and_b32 v217, 0xffff0000, v38
    v_lshlrev_b32 v218, 16, v39
    v_and_b32 v219, 0xffff0000, v39
    v_lshlrev_b32 v220, 16, v40
    v_and_b32 v221, 0xffff0000, v40
    v_lshlrev_b32 v222, 16, v41
    v_and_b32 v223, 0xffff0000, v41
    s_lshl_b32 s56, s44, 3
    s_lshl_b32 s53, s64, 1
    s_add_u32 s56, s56, s53
    s_lshr_b32 s57, s47, 1
    s_xor_b32 s53, s57, 0
    s_add_u32 s53, s53, s56
    s_lshl_b32 s53, s53, 4
    s_lshl_b32 s54, s47, 2
    s_add_u32 s53, s53, s54
    s_lshl_b32 s53, s53, 11
    s_add_u32 s82, s53, 2097152
    s_xor_b32 s53, s57, 1
    s_add_u32 s53, s53, s56
    s_lshl_b32 s53, s53, 4
    s_lshl_b32 s54, s47, 2
    s_add_u32 s53, s53, s54
    s_lshl_b32 s53, s53, 11
    s_add_u32 s83, s53, 2097152
    s_waitcnt vmcnt(0)
    s_cmp_eq_u32 s50, 1
    s_cbranch_scc0 Lfb_7
    buffer_store_dword v61, v54, s[40:43], 0 offen
    s_branch Ldn_8
Lfb_7:
    buffer_store_dword v61, v54, s[40:43], 0 offen sc1
Ldn_8:
    s_barrier
    v_mov_b32 v224, 0
    v_mov_b32 v225, 0
    v_mov_b32 v226, 0
    v_mov_b32 v227, 0
    v_mov_b32 v228, 0
    v_mov_b32 v229, 0
    v_mov_b32 v230, 0
    v_mov_b32 v231, 0
    v_mov_b32 v232, 0
    v_mov_b32 v233, 0
    v_mov_b32 v234, 0
    v_mov_b32 v235, 0
    v_mov_b32 v236, 0
    v_mov_b32 v237, 0
    v_mov_b32 v238, 0
    v_mov_b32 v239, 0
    s_lshl_b32 s53, s47, 6
    v_xor_b32 v140, s53, v12
    v_add_u32 v141, 65536, v140
    ds_read_b64_tr_b16 v[64:65], v140 offset:0
    ds_read_b64_tr_b16 v[66:67], v140 offset:2048
    ds_read_b64_tr_b16 v[68:69], v140 offset:4096
    ds_read_b64_tr_b16 v[70:71], v140 offset:6144
    ds_read_b64_tr_b16 v[72:73], v140 offset:8192
    ds_read_b64_tr_b16 v[74:75], v140 offset:10240
    ds_read_b64_tr_b16 v[76:77], v140 offset:12288
    ds_read_b64_tr_b16 v[78:79], v140 offset:14336
    ds_read_b64_tr_b16 v[80:81], v140 offset:16384
    ds_read_b64_tr_b16 v[82:83], v140 offset:18432
    ds_read_b64_tr_b16 v[84:85], v140 offset:20480
    ds_read_b64_tr_b16 v[86:87], v140 offset:22528
    ds_read_b64_tr_b16 v[88:89], v140 offset:24576
    ds_read_b64_tr_b16 v[90:91], v140 offset:26624
    ds_read_b64_tr_b16 v[92:93], v140 offset:28672
    ds_read_b64_tr_b16 v[94:95], v140 offset:30720
    s_waitcnt lgkmcnt(12)
    v_mfma_f32_4x4x4_16b_bf16 v[224:227], v[24:25], v[64:65], v[224:227]
    v_mfma_f32_4x4x4_16b_bf16 v[228:231], v[24:25], v[66:67], v[228:231]
    ds_read_b64_tr_b16 v[96:97], v140 offset:32768
    ds_read_b64_tr_b16 v[98:99], v140 offset:34816
    v_mfma_f32_4x4x4_16b_bf16 v[232:235], v[24:25], v[68:69], v[232:235]
    v_mfma_f32_4x4x4_16b_bf16 v[236:239], v[24:25], v[70:71], v[236:239]
    ds_read_b64_tr_b16 v[100:101], v140 offset:36864
    ds_read_b64_tr_b16 v[102:103], v140 offset:38912
    s_waitcnt lgkmcnt(12)
    v_mfma_f32_4x4x4_16b_bf16 v[224:227], v[24:25], v[72:73], v[224:227]
    v_mfma_f32_4x4x4_16b_bf16 v[228:231], v[24:25], v[74:75], v[228:231]
    ds_read_b64_tr_b16 v[104:105], v140 offset:40960
    ds_read_b64_tr_b16 v[106:107], v140 offset:43008
    v_mfma_f32_4x4x4_16b_bf16 v[232:235], v[24:25], v[76:77], v[232:235]
    v_mfma_f32_4x4x4_16b_bf16 v[236:239], v[24:25], v[78:79], v[236:239]
    ds_read_b64_tr_b16 v[108:109], v140 offset:45056
    ds_read_b64_tr_b16 v[110:111], v140 offset:47104
    s_waitcnt lgkmcnt(12)
    v_mfma_f32_4x4x4_16b_bf16 v[224:227], v[24:25], v[80:81], v[224:227]
    v_mfma_f32_4x4x4_16b_bf16 v[228:231], v[24:25], v[82:83], v[228:231]
    ds_read_b64_tr_b16 v[112:113], v140 offset:49152
    ds_read_b64_tr_b16 v[114:115], v140 offset:51200
    v_mfma_f32_4x4x4_16b_bf16 v[232:235], v[24:25], v[84:85], v[232:235]
    v_mfma_f32_4x4x4_16b_bf16 v[236:239], v[24:25], v[86:87], v[236:239]
    ds_read_b64_tr_b16 v[116:117], v140 offset:53248
    ds_read_b64_tr_b16 v[118:119], v140 offset:55296
    s_waitcnt lgkmcnt(12)
    v_mfma_f32_4x4x4_16b_bf16 v[224:227], v[24:25], v[88:89], v[224:227]
    v_mfma_f32_4x4x4_16b_bf16 v[228:231], v[24:25], v[90:91], v[228:231]
    v_mfma_f32_4x4x4_16b_bf16 v[232:235], v[24:25], v[92:93], v[232:235]
    v_mfma_f32_4x4x4_16b_bf16 v[236:239], v[24:25], v[94:95], v[236:239]
    s_waitcnt lgkmcnt(8)
    v_mfma_f32_4x4x4_16b_bf16 v[224:227], v[24:25], v[96:97], v[224:227]
    v_mfma_f32_4x4x4_16b_bf16 v[228:231], v[24:25], v[98:99], v[228:231]
    v_mfma_f32_4x4x4_16b_bf16 v[232:235], v[24:25], v[100:101], v[232:235]
    v_mfma_f32_4x4x4_16b_bf16 v[236:239], v[24:25], v[102:103], v[236:239]
    s_waitcnt lgkmcnt(4)
    v_mfma_f32_4x4x4_16b_bf16 v[224:227], v[24:25], v[104:105], v[224:227]
    v_mfma_f32_4x4x4_16b_bf16 v[228:231], v[24:25], v[106:107], v[228:231]
    v_mfma_f32_4x4x4_16b_bf16 v[232:235], v[24:25], v[108:109], v[232:235]
    v_mfma_f32_4x4x4_16b_bf16 v[236:239], v[24:25], v[110:111], v[236:239]
    s_waitcnt lgkmcnt(0)
    v_mfma_f32_4x4x4_16b_bf16 v[224:227], v[24:25], v[112:113], v[224:227]
    v_mfma_f32_4x4x4_16b_bf16 v[228:231], v[24:25], v[114:115], v[228:231]
    v_mfma_f32_4x4x4_16b_bf16 v[232:235], v[24:25], v[116:117], v[232:235]
    v_mfma_f32_4x4x4_16b_bf16 v[236:239], v[24:25], v[118:119], v[236:239]
    v_cndmask_b32 v42, v42, 0, s[72:73]
    v_accvgpr_write_b32 a240, v42
    v_accvgpr_write_b32 a241, 0
    v_accvgpr_write_b32 a242, 0
    v_accvgpr_write_b32 a243, 0
    v_accvgpr_read_b32 v52, a148
    v_accvgpr_read_b32 v53, a155
    v_accvgpr_read_b32 v56, a158
    v_accvgpr_read_b32 v54, a156
    v_accvgpr_read_b32 v57, a159
    v_accvgpr_read_b32 v55, a157
    v_accvgpr_read_b32 v58, a160
    s_mov_b32 s58, 0
Lpoll_9:
    buffer_load_dword v59, v52, s[40:43], 0 offen sc1
    s_waitcnt vmcnt(0)
    v_cmp_eq_u32 vcc, s49, v59
    s_nop 1
    s_cmp_eq_u64 vcc, -1
    s_cbranch_scc1 Lpd_10
    s_add_u32 s58, s58, 1
    s_cmp_lt_u32 s58, 0x40000
    s_cbranch_scc1 Lpoll_9
Lpd_10:
    buffer_load_dwordx4 v[96:99], v62, s[40:43], s83 offen offset:0
    buffer_load_dwordx4 v[100:103], v62, s[40:43], s83 offen offset:1024
    buffer_load_dwordx4 v[104:107], v62, s[40:43], s83 offen offset:2048
    buffer_load_dwordx4 v[108:111], v62, s[40:43], s83 offen offset:3072
    s_add_u32 s83, s83, 4096
    buffer_load_dwordx4 v[112:115], v62, s[40:43], s83 offen offset:0
    buffer_load_dwordx4 v[116:119], v62, s[40:43], s83 offen offset:1024
    buffer_load_dwordx4 v[120:123], v62, s[40:43], s83 offen offset:2048
    buffer_load_dwordx4 v[124:127], v62, s[40:43], s83 offen offset:3072
    buffer_load_dwordx4 v[64:67], v62, s[40:43], s82 offen offset:0
    buffer_load_dwordx4 v[68:71], v62, s[40:43], s82 offen offset:1024
    buffer_load_dwordx4 v[72:75], v62, s[40:43], s82 offen offset:2048
    buffer_load_dwordx4 v[76:79], v62, s[40:43], s82 offen offset:3072
    s_add_u32 s82, s82, 4096
    buffer_load_dwordx4 v[80:83], v62, s[40:43], s82 offen offset:0
    buffer_load_dwordx4 v[84:87], v62, s[40:43], s82 offen offset:1024
    buffer_load_dwordx4 v[88:91], v62, s[40:43], s82 offen offset:2048
    buffer_load_dwordx4 v[92:95], v62, s[40:43], s82 offen offset:3072
    v_accvgpr_read_b32 v44, a149
    v_accvgpr_read_b32 v45, a150
    v_mov_b32 v46, s49
    s_waitcnt vmcnt(15)
    v_mfma_f32_32x32x16_bf16 v[176:191], a[0:3], v[96:99], 0
    v_mfma_f32_32x32x16_bf16 v[192:207], a[4:7], v[96:99], 0
    s_waitcnt vmcnt(14)
    v_mfma_f32_32x32x16_bf16 v[176:191], a[8:11], v[100:103], v[176:191]
    v_mfma_f32_32x32x16_bf16 v[192:207], a[12:15], v[100:103], v[192:207]
    s_waitcnt vmcnt(13)
    v_mfma_f32_32x32x16_bf16 v[176:191], a[16:19], v[104:107], v[176:191]
    v_mfma_f32_32x32x16_bf16 v[192:207], a[20:23], v[104:107], v[192:207]
    s_waitcnt vmcnt(12)
    v_mfma_f32_32x32x16_bf16 v[176:191], a[24:27], v[108:111], v[176:191]
    v_mfma_f32_32x32x16_bf16 v[192:207], a[28:31], v[108:111], v[192:207]
    s_waitcnt vmcnt(11)
    v_mfma_f32_32x32x16_bf16 v[176:191], a[32:35], v[112:115], v[176:191]
    v_mfma_f32_32x32x16_bf16 v[192:207], a[36:39], v[112:115], v[192:207]
    s_waitcnt vmcnt(10)
    v_mfma_f32_32x32x16_bf16 v[176:191], a[40:43], v[116:119], v[176:191]
    v_mfma_f32_32x32x16_bf16 v[192:207], a[44:47], v[116:119], v[192:207]
    s_waitcnt vmcnt(9)
    v_mfma_f32_32x32x16_bf16 v[176:191], a[48:51], v[120:123], v[176:191]
    v_mfma_f32_32x32x16_bf16 v[192:207], a[52:55], v[120:123], v[192:207]
    s_waitcnt vmcnt(8)
    v_mfma_f32_32x32x16_bf16 v[176:191], a[56:59], v[124:127], v[176:191]
    v_mfma_f32_32x32x16_bf16 v[192:207], a[60:63], v[124:127], v[192:207]
    s_waitcnt vmcnt(7)
    v_mfma_f32_32x32x16_bf16 v[160:175], a[4:7], v[64:67], 0
    s_waitcnt vmcnt(6)
    v_mfma_f32_32x32x16_bf16 v[160:175], a[12:15], v[68:71], v[160:175]
    s_waitcnt vmcnt(5)
    v_mfma_f32_32x32x16_bf16 v[160:175], a[20:23], v[72:75], v[160:175]
    s_nop 4
    ds_write_b128 v54, v[176:179] offset:0
    s_waitcnt vmcnt(4)
    v_mfma_f32_32x32x16_bf16 v[160:175], a[28:31], v[76:79], v[160:175]
    ds_write_b128 v54, v[180:183] offset:1024
    s_waitcnt vmcnt(3)
    v_mfma_f32_32x32x16_bf16 v[160:175], a[36:39], v[80:83], v[160:175]
    ds_write_b128 v54, v[184:187] offset:2048
    s_waitcnt vmcnt(2)
    v_mfma_f32_32x32x16_bf16 v[160:175], a[44:47], v[84:87], v[160:175]
    ds_write_b128 v54, v[188:191] offset:3072
    s_waitcnt vmcnt(1)
    v_mfma_f32_32x32x16_bf16 v[160:175], a[52:55], v[88:91], v[160:175]
    ds_write_b128 v55, v[192:195] offset:0
    s_waitcnt vmcnt(0)
    v_mfma_f32_32x32x16_bf16 v[160:175], a[60:63], v[92:95], v[160:175]
    ds_write_b128 v55, v[196:199] offset:1024
    v_mfma_f32_32x32x16_bf16 v[144:159], a[0:3], v[64:67], v[208:223]
    ds_write_b128 v55, v[200:203] offset:2048
    v_mfma_f32_32x32x16_bf16 v[144:159], a[8:11], v[68:71], v[144:159]
    ds_write_b128 v55, v[204:207] offset:3072
    v_mfma_f32_32x32x16_bf16 v[144:159], a[16:19], v[72:75], v[144:159]
    v_mfma_f32_32x32x16_bf16 v[144:159], a[24:27], v[76:79], v[144:159]
    s_nop 4
    ds_write_b128 v53, v[160:163] offset:0
    v_mfma_f32_32x32x16_bf16 v[144:159], a[32:35], v[80:83], v[144:159]
    ds_write_b128 v53, v[164:167] offset:1024
    v_mfma_f32_32x32x16_bf16 v[144:159], a[40:43], v[84:87], v[144:159]
    ds_write_b128 v53, v[168:171] offset:2048
    v_mfma_f32_32x32x16_bf16 v[144:159], a[48:51], v[88:91], v[144:159]
    ds_write_b128 v53, v[172:175] offset:3072
    v_mfma_f32_32x32x16_bf16 v[144:159], a[56:59], v[92:95], v[144:159]
    s_waitcnt lgkmcnt(0)
    s_barrier
    ds_read_b128 v[64:67], v56 offset:0
    ds_read_b128 v[68:71], v56 offset:1024
    ds_read_b128 v[72:75], v56 offset:2048
    ds_read_b128 v[76:79], v56 offset:3072
    ds_read_b128 v[80:83], v57 offset:0
    ds_read_b128 v[84:87], v57 offset:1024
    ds_read_b128 v[88:91], v57 offset:2048
    ds_read_b128 v[92:95], v57 offset:3072
    ds_read_b128 v[96:99], v58 offset:0
    ds_read_b128 v[100:103], v58 offset:1024
    ds_read_b128 v[104:107], v58 offset:2048
    ds_read_b128 v[108:111], v58 offset:3072
    s_waitcnt lgkmcnt(8)
    v_pk_add_f32 v[144:145], v[144:145], v[64:65]
    v_pk_add_f32 v[146:147], v[146:147], v[66:67]
    v_pk_add_f32 v[148:149], v[148:149], v[68:69]
    v_pk_add_f32 v[150:151], v[150:151], v[70:71]
    v_pk_add_f32 v[152:153], v[152:153], v[72:73]
    v_pk_add_f32 v[154:155], v[154:155], v[74:75]
    v_pk_add_f32 v[156:157], v[156:157], v[76:77]
    v_pk_add_f32 v[158:159], v[158:159], v[78:79]
    s_waitcnt lgkmcnt(4)
    v_pk_add_f32 v[144:145], v[144:145], v[80:81]
    v_pk_add_f32 v[146:147], v[146:147], v[82:83]
    v_pk_add_f32 v[148:149], v[148:149], v[84:85]
    v_pk_add_f32 v[150:151], v[150:151], v[86:87]
    v_pk_add_f32 v[152:153], v[152:153], v[88:89]
    v_pk_add_f32 v[154:155], v[154:155], v[90:91]
    v_pk_add_f32 v[156:157], v[156:157], v[92:93]
    v_pk_add_f32 v[158:159], v[158:159], v[94:95]
    s_waitcnt lgkmcnt(0)
    v_pk_add_f32 v[144:145], v[144:145], v[96:97]
    v_pk_add_f32 v[146:147], v[146:147], v[98:99]
    v_pk_add_f32 v[148:149], v[148:149], v[100:101]
    v_pk_add_f32 v[150:151], v[150:151], v[102:103]
    v_pk_add_f32 v[152:153], v[152:153], v[104:105]
    v_pk_add_f32 v[154:155], v[154:155], v[106:107]
    v_pk_add_f32 v[156:157], v[156:157], v[108:109]
    v_pk_add_f32 v[158:159], v[158:159], v[110:111]
    v_cvt_pk_bf16_f32 v112, v144, v145
    v_cvt_pk_bf16_f32 v113, v146, v147
    v_cvt_pk_bf16_f32 v114, v148, v149
    v_cvt_pk_bf16_f32 v115, v150, v151
    v_cvt_pk_bf16_f32 v116, v152, v153
    v_cvt_pk_bf16_f32 v117, v154, v155
    v_cvt_pk_bf16_f32 v118, v156, v157
    v_cvt_pk_bf16_f32 v119, v158, v159
    s_cmp_eq_u32 s50, 1
    s_cbranch_scc0 Lfb_11
    buffer_store_dwordx4 v[112:115], v62, s[40:43], s85 offen
    buffer_store_dwordx4 v[116:119], v62, s[40:43], s85 offen offset:1024
    s_branch Ldn_12
Lfb_11:
    buffer_store_dwordx4 v[112:115], v62, s[40:43], s85 offen sc1
    buffer_store_dwordx4 v[116:119], v62, s[40:43], s85 offen offset:1024 sc1
Ldn_12:
    v_pk_mul_f32 v[64:65], v[144:145], v[144:145]
    v_pk_add_f32 v[66:67], v[144:145], v[146:147]
    v_pk_fma_f32 v[64:65], v[146:147], v[146:147], v[64:65]
    v_pk_add_f32 v[66:67], v[66:67], v[148:149]
    v_pk_fma_f32 v[64:65], v[148:149], v[148:149], v[64:65]
    v_pk_add_f32 v[66:67], v[66:67], v[150:151]
    v_pk_fma_f32 v[64:65], v[150:151], v[150:151], v[64:65]
    v_pk_add_f32 v[66:67], v[66:67], v[152:153]
    v_pk_fma_f32 v[64:65], v[152:153], v[152:153], v[64:65]
    v_pk_add_f32 v[66:67], v[66:67], v[154:155]
    v_pk_fma_f32 v[64:65], v[154:155], v[154:155], v[64:65]
    v_pk_add_f32 v[66:67], v[66:67], v[156:157]
    v_pk_fma_f32 v[64:65], v[156:157], v[156:157], v[64:65]
    v_pk_add_f32 v[66:67], v[66:67], v[158:159]
    v_pk_fma_f32 v[64:65], v[158:159], v[158:159], v[64:65]
    v_add_f32 v68, v66, v67
    v_add_f32 v69, v64, v65
    s_nop 1
    v_permlane32_swap_b32 v68, v69
    v_add_f32 v68, v68, v69
    v_mov_b32 v69, v68
    s_nop 1
    v_permlane32_swap_b32 v68, v69
    s_cmp_eq_u32 s50, 1
    s_cbranch_scc0 Lfb_13
    buffer_store_dwordx2 v[68:69], v45, s[40:43], s101 offen
    s_branch Ldn_14
Lfb_13:
    buffer_store_dwordx2 v[68:69], v45, s[40:43], s101 offen sc1
Ldn_14:
    v_mov_b32 v26, v144
    v_mov_b32 v27, v145
    v_mov_b32 v28, v146
    v_mov_b32 v29, v147
    v_mov_b32 v30, v148
    v_mov_b32 v31, v149
    v_mov_b32 v32, v150
    v_mov_b32 v33, v151
    v_mov_b32 v34, v152
    v_mov_b32 v35, v153
    v_mov_b32 v36, v154
    v_mov_b32 v37, v155
    v_mov_b32 v38, v156
    v_mov_b32 v39, v157
    v_mov_b32 v40, v158
    v_mov_b32 v41, v159
    s_lshl_b32 s56, s44, 3
    s_lshl_b32 s53, s66, 2
    s_add_u32 s56, s56, s53
    s_add_u32 s56, s56, s47
    s_mul_i32 s53, s56, 3584
    s_add_u32 s83, s53, 6291456
    s_mul_i32 s53, s56, 28672
    s_add_u32 s82, s53, 4194304
    s_mul_i32 s53, s56, 112
    s_lshl_b32 s54, s67, 3
    s_add_u32 s53, s53, s54
    s_lshl_b32 s53, s53, 10
    s_add_u32 s84, s53, 8388608
    s_waitcnt vmcnt(0)
    s_cmp_eq_u32 s50, 1
    s_cbranch_scc0 Lfb_15
    buffer_store_dword v46, v44, s[40:43], 0 offen
    s_branch Ldn_16
Lfb_15:
    buffer_store_dword v46, v44, s[40:43], 0 offen sc1
Ldn_16:
    s_lshl_b32 s53, s47, 6
    v_xor_b32 v140, s53, v12
    v_add_u32 v141, 65536, v140
    ds_read_b64_tr_b16 v[160:161], v140 offset:57344
    ds_read_b64_tr_b16 v[162:163], v140 offset:59392
    ds_read_b64_tr_b16 v[164:165], v140 offset:61440
    ds_read_b64_tr_b16 v[166:167], v140 offset:63488
    ds_read_b64_tr_b16 v[168:169], v141 offset:0
    ds_read_b64_tr_b16 v[170:171], v141 offset:2048
    ds_read_b64_tr_b16 v[172:173], v141 offset:4096
    ds_read_b64_tr_b16 v[174:175], v141 offset:6144
    ds_read_b64_tr_b16 v[176:177], v141 offset:8192
    ds_read_b64_tr_b16 v[178:179], v141 offset:10240
    ds_read_b64_tr_b16 v[180:181], v141 offset:12288
    ds_read_b64_tr_b16 v[182:183], v141 offset:14336
    ds_read_b64_tr_b16 v[184:185], v141 offset:16384
    ds_read_b64_tr_b16 v[186:187], v141 offset:18432
    ds_read_b64_tr_b16 v[188:189], v141 offset:20480
    ds_read_b64_tr_b16 v[190:191], v141 offset:22528
    s_waitcnt lgkmcnt(12)
    v_mfma_f32_4x4x4_16b_bf16 v[224:227], v[24:25], v[160:161], v[224:227]
    v_mfma_f32_4x4x4_16b_bf16 v[228:231], v[24:25], v[162:163], v[228:231]
    ds_read_b64_tr_b16 v[192:193], v141 offset:24576
    ds_read_b64_tr_b16 v[194:195], v141 offset:26624
    v_mfma_f32_4x4x4_16b_bf16 v[232:235], v[24:25], v[164:165], v[232:235]
    v_mfma_f32_4x4x4_16b_bf16 v[236:239], v[24:25], v[166:167], v[236:239]
    ds_read_b64_tr_b16 v[196:197], v141 offset:28672
    ds_read_b64_tr_b16 v[198:199], v141 offset:30720
    s_waitcnt lgkmcnt(12)
    v_mfma_f32_4x4x4_16b_bf16 v[224:227], v[24:25], v[168:169], v[224:227]
    v_mfma_f32_4x4x4_16b_bf16 v[228:231], v[24:25], v[170:171], v[228:231]
    ds_read_b64_tr_b16 v[200:201], v141 offset:32768
    ds_read_b64_tr_b16 v[202:203], v141 offset:34816
    v_mfma_f32_4x4x4_16b_bf16 v[232:235], v[24:25], v[172:173], v[232:235]
    v_mfma_f32_4x4x4_16b_bf16 v[236:239], v[24:25], v[174:175], v[236:239]
    ds_read_b64_tr_b16 v[204:205], v141 offset:36864
    ds_read_b64_tr_b16 v[206:207], v141 offset:38912
    s_waitcnt lgkmcnt(12)
    v_mfma_f32_4x4x4_16b_bf16 v[224:227], v[24:25], v[176:177], v[224:227]
    v_mfma_f32_4x4x4_16b_bf16 v[228:231], v[24:25], v[178:179], v[228:231]
    ds_read_b64_tr_b16 v[208:209], v141 offset:40960
    ds_read_b64_tr_b16 v[210:211], v141 offset:43008
    v_mfma_f32_4x4x4_16b_bf16 v[232:235], v[24:25], v[180:181], v[232:235]
    v_mfma_f32_4x4x4_16b_bf16 v[236:239], v[24:25], v[182:183], v[236:239]
    ds_read_b64_tr_b16 v[212:213], v141 offset:45056
    ds_read_b64_tr_b16 v[214:215], v141 offset:47104
    s_waitcnt lgkmcnt(12)
    v_mfma_f32_4x4x4_16b_bf16 v[224:227], v[24:25], v[184:185], v[224:227]
    v_mfma_f32_4x4x4_16b_bf16 v[228:231], v[24:25], v[186:187], v[228:231]
    v_mfma_f32_4x4x4_16b_bf16 v[232:235], v[24:25], v[188:189], v[232:235]
    v_mfma_f32_4x4x4_16b_bf16 v[236:239], v[24:25], v[190:191], v[236:239]
    s_waitcnt lgkmcnt(8)
    v_mfma_f32_4x4x4_16b_bf16 v[224:227], v[24:25], v[192:193], v[224:227]
    v_mfma_f32_4x4x4_16b_bf16 v[228:231], v[24:25], v[194:195], v[228:231]
    v_mfma_f32_4x4x4_16b_bf16 v[232:235], v[24:25], v[196:197], v[232:235]
    v_mfma_f32_4x4x4_16b_bf16 v[236:239], v[24:25], v[198:199], v[236:239]
    s_waitcnt lgkmcnt(4)
    v_mfma_f32_4x4x4_16b_bf16 v[224:227], v[24:25], v[200:201], v[224:227]
    v_mfma_f32_4x4x4_16b_bf16 v[228:231], v[24:25], v[202:203], v[228:231]
    v_mfma_f32_4x4x4_16b_bf16 v[232:235], v[24:25], v[204:205], v[232:235]
    v_mfma_f32_4x4x4_16b_bf16 v[236:239], v[24:25], v[206:207], v[236:239]
    s_waitcnt lgkmcnt(0)
    v_mfma_f32_4x4x4_16b_bf16 v[224:227], v[24:25], v[208:209], v[224:227]
    v_mfma_f32_4x4x4_16b_bf16 v[228:231], v[24:25], v[210:211], v[228:231]
    v_mfma_f32_4x4x4_16b_bf16 v[232:235], v[24:25], v[212:213], v[232:235]
    v_mfma_f32_4x4x4_16b_bf16 v[236:239], v[24:25], v[214:215], v[236:239]
    v_accvgpr_read_b32 v141, a163
    s_nop 1
    v_add_f32 v140, v224, v228
    s_nop 0
    v_add_f32 v142, v232, v236
    v_add_f32 v140, v140, v142
    v_mov_b32 v142, v140
    v_cndmask_b32 v7, v7, 0, s[72:73]
    s_nop 0
    v_permlane32_swap_b32 v140, v142
    v_add_f32 v140, v140, v142
    v_cndmask_b32 v148, v140, 0, s[72:73]
    v_cvt_pk_bf16_f32 v144, v148, v148
    v_lshlrev_b32 v149, 16, v144
    v_sub_f32 v149, v148, v149
    v_cvt_pk_bf16_f32 v145, v149, 0
    v_lshl_or_b32 v145, v7, 16, v145
    v_mov_b32 v146, v7
    v_mov_b32 v147, 0
    ds_write_b128 v141, v[144:147] offset:4096
    v_accvgpr_read_b32 v52, a151
    v_accvgpr_read_b32 v54, a152
    v_add_u32 v24, 65536, v12
    v_add_u32 v25, 65536, v13
    v_add_u32 v42, 65536, v14
    v_add_u32 v43, 65536, v15
    s_waitcnt lgkmcnt(0)
    s_barrier
    ds_read_b128 a[224:227], v62 offset:4096
    ds_read_b128 a[228:231], v62 offset:5120
    ds_read_b128 a[232:235], v62 offset:6144
    ds_read_b128 a[236:239], v62 offset:7168
    s_mov_b32 s58, 0
Lpoll_17:
    buffer_load_dword v53, v52, s[40:43], 0 offen sc1
    s_waitcnt vmcnt(0)
    v_cmp_eq_u32 vcc, s49, v53
    s_nop 1
    s_cmp_eq_u64 vcc, -1
    s_cbranch_scc1 Lpd_18
    s_add_u32 s58, s58, 1
    s_cmp_lt_u32 s58, 0x40000
    s_cbranch_scc1 Lpoll_17
Lpd_18:
    buffer_load_dwordx4 v[128:131], v62, s[40:43], s82 offen offset:0
    buffer_load_dwordx4 v[132:135], v62, s[40:43], s82 offen offset:1024
    buffer_load_dwordx4 v[136:139], v62, s[40:43], s82 offen offset:2048
    buffer_load_dwordx4 v[140:143], v62, s[40:43], s82 offen offset:3072
    s_add_u32 s82, s82, 4096
    buffer_load_dwordx4 v[144:147], v62, s[40:43], s82 offen offset:0
    buffer_load_dwordx4 v[148:151], v62, s[40:43], s82 offen offset:1024
    buffer_load_dwordx4 v[152:155], v62, s[40:43], s82 offen offset:2048
    buffer_load_dwordx4 v[156:159], v62, s[40:43], s82 offen offset:3072
    s_add_u32 s82, s82, 4096
    buffer_load_dwordx4 v[160:163], v62, s[40:43], s82 offen offset:0
    buffer_load_dwordx4 v[164:167], v62, s[40:43], s82 offen offset:1024
    buffer_load_dwordx2 v[192:193], v54, s[40:43], s83 offen offset:0
    buffer_load_dwordx2 v[194:195], v54, s[40:43], s83 offen offset:256
    buffer_load_dwordx2 v[196:197], v54, s[40:43], s83 offen offset:512
    buffer_load_dwordx2 v[198:199], v54, s[40:43], s83 offen offset:768
    buffer_load_dwordx2 v[200:201], v54, s[40:43], s83 offen offset:1024
    buffer_load_dwordx2 v[202:203], v54, s[40:43], s83 offen offset:1280
    buffer_load_dwordx2 v[204:205], v54, s[40:43], s83 offen offset:1536
    ds_read_b64_tr_b16 v[240:241], v12 offset:0
    ds_read_b64_tr_b16 v[242:243], v12 offset:2048
    ds_read_b64_tr_b16 v[244:245], v13 offset:0
    ds_read_b64_tr_b16 v[246:247], v13 offset:2048
    ds_read_b64_tr_b16 v[248:249], v14 offset:0
    ds_read_b64_tr_b16 v[250:251], v14 offset:2048
    ds_read_b64_tr_b16 v[252:253], v15 offset:0
    ds_read_b64_tr_b16 v[254:255], v15 offset:2048
    s_waitcnt vmcnt(16) lgkmcnt(6)
    v_mfma_f32_32x32x16_bf16 v[64:79], v[240:243], v[128:131], 0
    ds_read_b64_tr_b16 v[46:47], v12 offset:4096
    ds_read_b64_tr_b16 v[48:49], v12 offset:6144
    buffer_load_dwordx4 v[168:171], v62, s[40:43], s82 offen offset:2048
    s_waitcnt lgkmcnt(6)
    v_mfma_f32_32x32x16_bf16 v[80:95], v[244:247], v[128:131], 0
    ds_read_b64_tr_b16 v[50:51], v13 offset:4096
    ds_read_b64_tr_b16 v[52:53], v13 offset:6144
    s_add_u32 m0, s93, 0
    s_add_u32 s59, s95, 0
    buffer_load_dwordx4 v4, s[28:31], s59 offen lds
    s_waitcnt lgkmcnt(6)
    v_mfma_f32_32x32x16_bf16 v[96:111], v[248:251], v[128:131], 0
    ds_read_b64_tr_b16 v[54:55], v14 offset:4096
    ds_read_b64_tr_b16 v[56:57], v14 offset:6144
    s_waitcnt lgkmcnt(6)
    v_mfma_f32_32x32x16_bf16 v[112:127], v[252:255], v[128:131], 0
    ds_read_b64_tr_b16 v[58:59], v15 offset:4096
    ds_read_b64_tr_b16 v[60:61], v15 offset:6144
    s_waitcnt vmcnt(17) lgkmcnt(6)
    v_mfma_f32_32x32x16_bf16 v[64:79], v[46:49], v[132:135], v[64:79]
    ds_read_b64_tr_b16 v[240:241], v12 offset:8192
    ds_read_b64_tr_b16 v[242:243], v12 offset:10240
    buffer_load_dwordx4 v[172:175], v62, s[40:43], s82 offen offset:3072
    s_waitcnt lgkmcnt(6)
    v_mfma_f32_32x32x16_bf16 v[80:95], v[50:53], v[132:135], v[80:95]
    ds_read_b64_tr_b16 v[244:245], v13 offset:8192
    ds_read_b64_tr_b16 v[246:247], v13 offset:10240
    s_add_u32 m0, s93, 1024
    s_add_u32 s59, s95, 7168
    buffer_load_dwordx4 v4, s[28:31], s59 offen lds
    s_waitcnt lgkmcnt(6)
    v_mfma_f32_32x32x16_bf16 v[96:111], v[54:57], v[132:135], v[96:111]
    ds_read_b64_tr_b16 v[248:249], v14 offset:8192
    ds_read_b64_tr_b16 v[250:251], v14 offset:10240
    s_waitcnt lgkmcnt(6)
    v_mfma_f32_32x32x16_bf16 v[112:127], v[58:61], v[132:135], v[112:127]
    ds_read_b64_tr_b16 v[252:253], v15 offset:8192
    ds_read_b64_tr_b16 v[254:255], v15 offset:10240
    s_waitcnt vmcnt(18) lgkmcnt(6)
    v_mfma_f32_32x32x16_bf16 v[64:79], v[240:243], v[136:139], v[64:79]
    ds_read_b64_tr_b16 v[46:47], v12 offset:12288
    ds_read_b64_tr_b16 v[48:49], v12 offset:14336
    s_add_u32 s82, s82, 4096
    buffer_load_dwordx4 v[176:179], v62, s[40:43], s82 offen offset:0
    s_waitcnt lgkmcnt(6)
    v_mfma_f32_32x32x16_bf16 v[80:95], v[244:247], v[136:139], v[80:95]
    ds_read_b64_tr_b16 v[50:51], v13 offset:12288
    ds_read_b64_tr_b16 v[52:53], v13 offset:14336
    s_add_u32 m0, s93, 2048
    s_add_u32 s59, s95, 14336
    buffer_load_dwordx4 v4, s[28:31], s59 offen lds
    s_waitcnt lgkmcnt(6)
    v_mfma_f32_32x32x16_bf16 v[96:111], v[248:251], v[136:139], v[96:111]
    ds_read_b64_tr_b16 v[54:55], v14 offset:12288
    ds_read_b64_tr_b16 v[56:57], v14 offset:14336
    s_waitcnt lgkmcnt(6)
    v_mfma_f32_32x32x16_bf16 v[112:127], v[252:255], v[136:139], v[112:127]
    ds_read_b64_tr_b16 v[58:59], v15 offset:12288
    ds_read_b64_tr_b16 v[60:61], v15 offset:14336
    s_waitcnt vmcnt(19) lgkmcnt(6)
    v_mfma_f32_32x32x16_bf16 v[64:79], v[46:49], v[140:143], v[64:79]
    ds_read_b64_tr_b16 v[240:241], v12 offset:16384
    ds_read_b64_tr_b16 v[242:243], v12 offset:18432
    buffer_load_dwordx4 v[180:183], v62, s[40:43], s82 offen offset:1024
    s_waitcnt lgkmcnt(6)
    v_mfma_f32_32x32x16_bf16 v[80:95], v[50:53], v[140:143], v[80:95]
    ds_read_b64_tr_b16 v[244:245], v13 offset:16384
    ds_read_b64_tr_b16 v[246:247], v13 offset:18432
    s_add_u32 m0, s93, 3072
    s_add_u32 s59, s95, 21504
    buffer_load_dwordx4 v4, s[28:31], s59 offen lds
    s_waitcnt lgkmcnt(6)
    v_mfma_f32_32x32x16_bf16 v[96:111], v[54:57], v[140:143], v[96:111]
    ds_read_b64_tr_b16 v[248:249], v14 offset:16384
    ds_read_b64_tr_b16 v[250:251], v14 offset:18432
    s_waitcnt lgkmcnt(6)
    v_mfma_f32_32x32x16_bf16 v[112:127], v[58:61], v[140:143], v[112:127]
    ds_read_b64_tr_b16 v[252:253], v15 offset:16384
    ds_read_b64_tr_b16 v[254:255], v15 offset:18432
    s_waitcnt vmcnt(20) lgkmcnt(6)
    v_mfma_f32_32x32x16_bf16 v[64:79], v[240:243], v[144:147], v[64:79]
    ds_read_b64_tr_b16 v[46:47], v12 offset:20480
    ds_read_b64_tr_b16 v[48:49], v12 offset:22528
    s_waitcnt vmcnt(8)
    v_add_f32 v192, v192, v194
    v_add_f32 v193, v193, v195
    buffer_load_dwordx4 v[184:187], v62, s[40:43], s82 offen offset:2048
    s_waitcnt lgkmcnt(6)
    v_mfma_f32_32x32x16_bf16 v[80:95], v[244:247], v[144:147], v[80:95]
    ds_read_b64_tr_b16 v[50:51], v13 offset:20480
    ds_read_b64_tr_b16 v[52:53], v13 offset:22528
    v_add_f32 v192, v192, v196
    v_add_f32 v193, v193, v197
    s_add_u32 m0, s93, 4096
    s_add_u32 s59, s95, 28672
    buffer_load_dwordx4 v4, s[28:31], s59 offen lds
    s_waitcnt lgkmcnt(6)
    v_mfma_f32_32x32x16_bf16 v[96:111], v[248:251], v[144:147], v[96:111]
    ds_read_b64_tr_b16 v[54:55], v14 offset:20480
    ds_read_b64_tr_b16 v[56:57], v14 offset:22528
    v_add_f32 v192, v192, v198
    v_add_f32 v193, v193, v199
    s_waitcnt lgkmcnt(6)
    v_mfma_f32_32x32x16_bf16 v[112:127], v[252:255], v[144:147], v[112:127]
    ds_read_b64_tr_b16 v[58:59], v15 offset:20480
    ds_read_b64_tr_b16 v[60:61], v15 offset:22528
    v_add_f32 v192, v192, v200
    v_add_f32 v193, v193, v201
    s_waitcnt vmcnt(21) lgkmcnt(6)
    v_mfma_f32_32x32x16_bf16 v[64:79], v[46:49], v[148:151], v[64:79]
    ds_read_b64_tr_b16 v[240:241], v12 offset:24576
    ds_read_b64_tr_b16 v[242:243], v12 offset:26624
    v_add_f32 v192, v192, v202
    v_add_f32 v193, v193, v203
    buffer_load_dwordx4 v[188:191], v62, s[40:43], s82 offen offset:3072
    s_waitcnt lgkmcnt(6)
    v_mfma_f32_32x32x16_bf16 v[80:95], v[50:53], v[148:151], v[80:95]
    ds_read_b64_tr_b16 v[244:245], v13 offset:24576
    ds_read_b64_tr_b16 v[246:247], v13 offset:26624
    v_add_f32 v192, v192, v204
    v_add_f32 v193, v193, v205
    s_add_u32 m0, s93, 5120
    s_add_u32 s59, s95, 35840
    buffer_load_dwordx4 v4, s[28:31], s59 offen lds
    s_waitcnt lgkmcnt(6)
    v_mfma_f32_32x32x16_bf16 v[96:111], v[54:57], v[148:151], v[96:111]
    ds_read_b64_tr_b16 v[248:249], v14 offset:24576
    ds_read_b64_tr_b16 v[250:251], v14 offset:26624
    v_mov_b32 v194, v192
    v_mov_b32 v195, v193
    s_waitcnt lgkmcnt(6)
    v_mfma_f32_32x32x16_bf16 v[112:127], v[58:61], v[148:151], v[112:127]
    ds_read_b64_tr_b16 v[252:253], v15 offset:24576
    ds_read_b64_tr_b16 v[254:255], v15 offset:26624
    v_permlane32_swap_b32 v192, v194
    v_permlane32_swap_b32 v193, v195
    s_waitcnt vmcnt(22) lgkmcnt(6)
    v_mfma_f32_32x32x16_bf16 v[64:79], v[240:243], v[152:155], v[64:79]
    ds_read_b64_tr_b16 v[46:47], v12 offset:28672
    ds_read_b64_tr_b16 v[48:49], v12 offset:30720
    v_add_f32 v192, v192, v194
    v_add_f32 v193, v193, v195
    s_add_u32 s82, s82, 4096
    buffer_load_dwordx4 v[128:131], v62, s[40:43], s82 offen offset:0
    s_waitcnt lgkmcnt(6)
    v_mfma_f32_32x32x16_bf16 v[80:95], v[244:247], v[152:155], v[80:95]
    ds_read_b64_tr_b16 v[50:51], v13 offset:28672
    ds_read_b64_tr_b16 v[52:53], v13 offset:30720
    v_mul_f32 v196, 0x3b124925, v192
    v_mul_f32 v197, 0x3b124925, v193
    s_add_u32 m0, s93, 6144
    s_add_u32 s59, s95, 43008
    buffer_load_dwordx4 v4, s[28:31], s59 offen lds
    s_waitcnt lgkmcnt(6)
    v_mfma_f32_32x32x16_bf16 v[96:111], v[248:251], v[152:155], v[96:111]
    ds_read_b64_tr_b16 v[54:55], v14 offset:28672
    ds_read_b64_tr_b16 v[56:57], v14 offset:30720
    v_fma_f32 v197, -v196, v196, v197
    v_add_f32 v197, 0x3727c5ac, v197
    s_waitcnt lgkmcnt(6)
    v_mfma_f32_32x32x16_bf16 v[112:127], v[252:255], v[152:155], v[112:127]
    ds_read_b64_tr_b16 v[58:59], v15 offset:28672
    ds_read_b64_tr_b16 v[60:61], v15 offset:30720
    v_rsq_f32 v199, v197
    v_sub_f32 v196, 0, v196
    s_waitcnt vmcnt(23) lgkmcnt(6)
    v_mfma_f32_32x32x16_bf16 v[64:79], v[46:49], v[156:159], v[64:79]
    ds_read_b64_tr_b16 v[240:241], v12 offset:32768
    ds_read_b64_tr_b16 v[242:243], v12 offset:34816
    v_mul_f32 v198, v197, v199
    v_cndmask_b32 v200, v196, 0, s[72:73]
    buffer_load_dwordx4 v[132:135], v62, s[40:43], s82 offen offset:1024
    s_waitcnt lgkmcnt(6)
    v_mfma_f32_32x32x16_bf16 v[80:95], v[50:53], v[156:159], v[80:95]
    ds_read_b64_tr_b16 v[244:245], v13 offset:32768
    ds_read_b64_tr_b16 v[246:247], v13 offset:34816
    v_cndmask_b32 v201, v198, 0, s[72:73]
    v_cvt_pk_bf16_f32 v17, v200, v201
    s_add_u32 m0, s93, 7168
    s_add_u32 s59, s95, 50176
    buffer_load_dwordx4 v4, s[28:31], s59 offen lds
    s_waitcnt lgkmcnt(6)
    v_mfma_f32_32x32x16_bf16 v[96:111], v[54:57], v[156:159], v[96:111]
    ds_read_b64_tr_b16 v[248:249], v14 offset:32768
    ds_read_b64_tr_b16 v[250:251], v14 offset:34816
    v_lshlrev_b32 v202, 16, v17
    v_sub_f32 v202, v200, v202
    s_waitcnt lgkmcnt(6)
    v_mfma_f32_32x32x16_bf16 v[112:127], v[58:61], v[156:159], v[112:127]
    ds_read_b64_tr_b16 v[252:253], v15 offset:32768
    ds_read_b64_tr_b16 v[254:255], v15 offset:34816
    v_and_b32 v203, 0xffff0000, v17
    v_sub_f32 v203, v201, v203
    s_waitcnt vmcnt(24) lgkmcnt(6)
    v_mfma_f32_32x32x16_bf16 v[64:79], v[240:243], v[160:163], v[64:79]
    ds_read_b64_tr_b16 v[46:47], v12 offset:36864
    ds_read_b64_tr_b16 v[48:49], v12 offset:38912
    v_cvt_pk_bf16_f32 v16, v200, v202
    v_cvt_pk_bf16_f32 v18, v203, 0
    buffer_load_dwordx4 v[136:139], v62, s[40:43], s82 offen offset:2048
    s_waitcnt lgkmcnt(6)
    v_mfma_f32_32x32x16_bf16 v[80:95], v[244:247], v[160:163], v[80:95]
    ds_read_b64_tr_b16 v[50:51], v13 offset:36864
    ds_read_b64_tr_b16 v[52:53], v13 offset:38912
    v_mov_b32 v19, 0
    v_mul_f32 v20, 0xc0135761, v199
    s_add_u32 m0, s93, 8192
    s_add_u32 s59, s95, 57344
    buffer_load_dwordx4 v4, s[28:31], s59 offen lds
    s_waitcnt lgkmcnt(6)
    v_mfma_f32_32x32x16_bf16 v[96:111], v[248:251], v[160:163], v[96:111]
    ds_read_b64_tr_b16 v[54:55], v14 offset:36864
    ds_read_b64_tr_b16 v[56:57], v14 offset:38912
    v_mul_f32 v22, v199, v199
    v_mul_f32 v22, v22, v20
    s_waitcnt vmcnt(14)
    ds_read_b64_tr_b16 a[0:1], v10 offset:0
    s_waitcnt lgkmcnt(7)
    v_mfma_f32_32x32x16_bf16 v[112:127], v[252:255], v[160:163], v[112:127]
    ds_read_b64_tr_b16 v[58:59], v15 offset:36864
    ds_read_b64_tr_b16 v[60:61], v15 offset:38912
    v_mul_f32 v22, 0x3d372713, v22
    v_mov_b32 v44, v198
    ds_read_b64_tr_b16 a[2:3], v10 offset:1024
    s_waitcnt vmcnt(25) lgkmcnt(8)
    v_mfma_f32_32x32x16_bf16 v[64:79], v[46:49], v[164:167], v[64:79]
    ds_read_b64_tr_b16 v[240:241], v12 offset:40960
    ds_read_b64_tr_b16 v[242:243], v12 offset:43008
    buffer_load_dwordx4 v[140:143], v62, s[40:43], s82 offen offset:3072
    s_waitcnt lgkmcnt(8)
    v_mfma_f32_32x32x16_bf16 v[80:95], v[50:53], v[164:167], v[80:95]
    ds_read_b64_tr_b16 v[244:245], v13 offset:40960
    ds_read_b64_tr_b16 v[246:247], v13 offset:43008
    s_add_u32 m0, s93, 9216
    s_add_u32 s59, s95, 64512
    buffer_load_dwordx4 v4, s[28:31], s59 offen lds
    s_waitcnt lgkmcnt(8)
    v_mfma_f32_32x32x16_bf16 v[96:111], v[54:57], v[164:167], v[96:111]
    ds_read_b64_tr_b16 v[248:249], v14 offset:40960
    ds_read_b64_tr_b16 v[250:251], v14 offset:43008
    ds_read_b64_tr_b16 a[4:5], v11 offset:0
    s_waitcnt lgkmcnt(8)
    v_mfma_f32_32x32x16_bf16 v[112:127], v[58:61], v[164:167], v[112:127]
    ds_read_b64_tr_b16 v[252:253], v15 offset:40960
    ds_read_b64_tr_b16 v[254:255], v15 offset:43008
    ds_read_b64_tr_b16 a[6:7], v11 offset:1024
    s_waitcnt vmcnt(19) lgkmcnt(8)
    v_mfma_f32_32x32x16_bf16 v[64:79], v[240:243], v[168:171], v[64:79]
    ds_read_b64_tr_b16 v[46:47], v12 offset:45056
    ds_read_b64_tr_b16 v[48:49], v12 offset:47104
    s_add_u32 s82, s82, 4096
    buffer_load_dwordx4 v[144:147], v62, s[40:43], s82 offen offset:0
    s_waitcnt lgkmcnt(8)
    v_mfma_f32_32x32x16_bf16 v[80:95], v[244:247], v[168:171], v[80:95]
    ds_read_b64_tr_b16 v[50:51], v13 offset:45056
    ds_read_b64_tr_b16 v[52:53], v13 offset:47104
    s_waitcnt vmcnt(13)
    ds_read_b64_tr_b16 a[8:9], v10 offset:2048
    ds_read_b64_tr_b16 a[10:11], v10 offset:3072
    ds_read_b64_tr_b16 a[12:13], v11 offset:2048
    ds_read_b64_tr_b16 a[14:15], v11 offset:3072
    s_waitcnt lgkmcnt(8)
    s_add_u32 m0, s93, 0
    s_add_u32 s59, s95, 71680
    buffer_load_dwordx4 v4, s[28:31], s59 offen lds
    s_waitcnt lgkmcnt(12)
    v_mfma_f32_32x32x16_bf16 v[96:111], v[248:251], v[168:171], v[96:111]
    ds_read_b64_tr_b16 v[54:55], v14 offset:45056
    ds_read_b64_tr_b16 v[56:57], v14 offset:47104
    s_waitcnt lgkmcnt(11)
    v_mfma_f32_32x32x16_bf16 v[112:127], v[252:255], v[168:171], v[112:127]
    ds_read_b64_tr_b16 v[58:59], v15 offset:45056
    ds_read_b64_tr_b16 v[60:61], v15 offset:47104
    s_waitcnt vmcnt(19) lgkmcnt(10)
    v_mfma_f32_32x32x16_bf16 v[64:79], v[46:49], v[172:175], v[64:79]
    ds_read_b64_tr_b16 v[240:241], v12 offset:49152
    ds_read_b64_tr_b16 v[242:243], v12 offset:51200
    buffer_load_dwordx4 v[148:151], v62, s[40:43], s82 offen offset:1024
    s_waitcnt lgkmcnt(10)
    v_mfma_f32_32x32x16_bf16 v[80:95], v[50:53], v[172:175], v[80:95]
    ds_read_b64_tr_b16 v[244:245], v13 offset:49152
    ds_read_b64_tr_b16 v[246:247], v13 offset:51200
    s_add_u32 m0, s93, 1024
    s_add_u32 s59, s95, 78848
    buffer_load_dwordx4 v4, s[28:31], s59 offen lds
    s_waitcnt lgkmcnt(6)
    v_mfma_f32_32x32x16_bf16 v[96:111], v[54:57], v[172:175], v[96:111]
    ds_read_b64_tr_b16 v[248:249], v14 offset:49152
    ds_read_b64_tr_b16 v[250:251], v14 offset:51200
    s_waitcnt lgkmcnt(6)
    v_mfma_f32_32x32x16_bf16 v[112:127], v[58:61], v[172:175], v[112:127]
    ds_read_b64_tr_b16 v[252:253], v15 offset:49152
    ds_read_b64_tr_b16 v[254:255], v15 offset:51200
    s_waitcnt vmcnt(19) lgkmcnt(6)
    v_mfma_f32_32x32x16_bf16 v[64:79], v[240:243], v[176:179], v[64:79]
    ds_read_b64_tr_b16 v[46:47], v12 offset:53248
    ds_read_b64_tr_b16 v[48:49], v12 offset:55296
    buffer_load_dwordx4 v[152:155], v62, s[40:43], s82 offen offset:2048
    s_waitcnt lgkmcnt(6)
    v_mfma_f32_32x32x16_bf16 v[80:95], v[244:247], v[176:179], v[80:95]
    ds_read_b64_tr_b16 v[50:51], v13 offset:53248
    ds_read_b64_tr_b16 v[52:53], v13 offset:55296
    s_waitcnt vmcnt(13)
    ds_read_b64_tr_b16 a[16:17], v10 offset:4096
    ds_read_b64_tr_b16 a[18:19], v10 offset:5120
    ds_read_b64_tr_b16 a[20:21], v11 offset:4096
    ds_read_b64_tr_b16 a[22:23], v11 offset:5120
    s_waitcnt lgkmcnt(15)
    s_add_u32 m0, s93, 2048
    s_add_u32 s59, s95, 86016
    buffer_load_dwordx4 v4, s[28:31], s59 offen lds
    s_waitcnt lgkmcnt(10)
    v_mfma_f32_32x32x16_bf16 v[96:111], v[248:251], v[176:179], v[96:111]
    ds_read_b64_tr_b16 v[54:55], v14 offset:53248
    ds_read_b64_tr_b16 v[56:57], v14 offset:55296
    s_waitcnt lgkmcnt(10)
    v_mfma_f32_32x32x16_bf16 v[112:127], v[252:255], v[176:179], v[112:127]
    ds_read_b64_tr_b16 v[58:59], v15 offset:53248
    ds_read_b64_tr_b16 v[60:61], v15 offset:55296
    s_waitcnt vmcnt(19) lgkmcnt(10)
    v_mfma_f32_32x32x16_bf16 v[64:79], v[46:49], v[180:183], v[64:79]
    ds_read_b64_tr_b16 v[240:241], v12 offset:57344
    ds_read_b64_tr_b16 v[242:243], v12 offset:59392
    buffer_load_dwordx4 v[156:159], v62, s[40:43], s82 offen offset:3072
    s_waitcnt lgkmcnt(10)
    v_mfma_f32_32x32x16_bf16 v[80:95], v[50:53], v[180:183], v[80:95]
    ds_read_b64_tr_b16 v[244:245], v13 offset:57344
    ds_read_b64_tr_b16 v[246:247], v13 offset:59392
    s_add_u32 m0, s93, 3072
    s_add_u32 s59, s95, 93184
    buffer_load_dwordx4 v4, s[28:31], s59 offen lds
    s_waitcnt lgkmcnt(6)
    v_mfma_f32_32x32x16_bf16 v[96:111], v[54:57], v[180:183], v[96:111]
    ds_read_b64_tr_b16 v[248:249], v14 offset:57344
    ds_read_b64_tr_b16 v[250:251], v14 offset:59392
    s_waitcnt lgkmcnt(6)
    v_mfma_f32_32x32x16_bf16 v[112:127], v[58:61], v[180:183], v[112:127]
    ds_read_b64_tr_b16 v[252:253], v15 offset:57344
    ds_read_b64_tr_b16 v[254:255], v15 offset:59392
    s_waitcnt vmcnt(19) lgkmcnt(6)
    v_mfma_f32_32x32x16_bf16 v[64:79], v[240:243], v[184:187], v[64:79]
    ds_read_b64_tr_b16 v[46:47], v12 offset:61440
    ds_read_b64_tr_b16 v[48:49], v12 offset:63488
    s_add_u32 s82, s82, 4096
    buffer_load_dwordx4 v[160:163], v62, s[40:43], s82 offen offset:0
    s_waitcnt lgkmcnt(6)
    v_mfma_f32_32x32x16_bf16 v[80:95], v[244:247], v[184:187], v[80:95]
    ds_read_b64_tr_b16 v[50:51], v13 offset:61440
    ds_read_b64_tr_b16 v[52:53], v13 offset:63488
    s_waitcnt vmcnt(13)
    ds_read_b64_tr_b16 a[24:25], v10 offset:6144
    ds_read_b64_tr_b16 a[26:27], v10 offset:7168
    ds_read_b64_tr_b16 a[28:29], v11 offset:6144
    ds_read_b64_tr_b16 a[30:31], v11 offset:7168
    s_waitcnt lgkmcnt(15)
    s_add_u32 m0, s93, 4096
    s_add_u32 s59, s95, 100352
    buffer_load_dwordx4 v4, s[28:31], s59 offen lds
    s_waitcnt lgkmcnt(10)
    v_mfma_f32_32x32x16_bf16 v[96:111], v[248:251], v[184:187], v[96:111]
    ds_read_b64_tr_b16 v[54:55], v14 offset:61440
    ds_read_b64_tr_b16 v[56:57], v14 offset:63488
    s_waitcnt lgkmcnt(10)
    v_mfma_f32_32x32x16_bf16 v[112:127], v[252:255], v[184:187], v[112:127]
    ds_read_b64_tr_b16 v[58:59], v15 offset:61440
    ds_read_b64_tr_b16 v[60:61], v15 offset:63488
    s_waitcnt vmcnt(19) lgkmcnt(10)
    v_mfma_f32_32x32x16_bf16 v[64:79], v[46:49], v[188:191], v[64:79]
    ds_read_b64_tr_b16 v[240:241], v24 offset:0
    ds_read_b64_tr_b16 v[242:243], v24 offset:2048
    buffer_load_dwordx4 v[164:167], v62, s[40:43], s82 offen offset:1024
    s_waitcnt lgkmcnt(10)
    v_mfma_f32_32x32x16_bf16 v[80:95], v[50:53], v[188:191], v[80:95]
    ds_read_b64_tr_b16 v[244:245], v25 offset:0
    ds_read_b64_tr_b16 v[246:247], v25 offset:2048
    s_add_u32 m0, s93, 5120
    s_add_u32 s59, s95, 107520
    buffer_load_dwordx4 v4, s[28:31], s59 offen lds
    s_waitcnt lgkmcnt(6)
    v_mfma_f32_32x32x16_bf16 v[96:111], v[54:57], v[188:191], v[96:111]
    ds_read_b64_tr_b16 v[248:249], v42 offset:0
    ds_read_b64_tr_b16 v[250:251], v42 offset:2048
    s_waitcnt lgkmcnt(6)
    v_mfma_f32_32x32x16_bf16 v[112:127], v[58:61], v[188:191], v[112:127]
    ds_read_b64_tr_b16 v[252:253], v43 offset:0
    ds_read_b64_tr_b16 v[254:255], v43 offset:2048
    s_waitcnt vmcnt(19) lgkmcnt(6)
    v_mfma_f32_32x32x16_bf16 v[64:79], v[240:243], v[128:131], v[64:79]
    ds_read_b64_tr_b16 v[46:47], v24 offset:4096
    ds_read_b64_tr_b16 v[48:49], v24 offset:6144
    buffer_load_dwordx4 v[168:171], v62, s[40:43], s82 offen offset:2048
    s_waitcnt lgkmcnt(6)
    v_mfma_f32_32x32x16_bf16 v[80:95], v[244:247], v[128:131], v[80:95]
    ds_read_b64_tr_b16 v[50:51], v25 offset:4096
    ds_read_b64_tr_b16 v[52:53], v25 offset:6144
    s_waitcnt vmcnt(13)
    ds_read_b64_tr_b16 a[32:33], v10 offset:8192
    ds_read_b64_tr_b16 a[34:35], v10 offset:9216
    ds_read_b64_tr_b16 a[36:37], v11 offset:8192
    ds_read_b64_tr_b16 a[38:39], v11 offset:9216
    s_waitcnt lgkmcnt(15)
    s_add_u32 m0, s93, 6144
    s_add_u32 s59, s95, 114688
    buffer_load_dwordx4 v4, s[28:31], s59 offen lds
    s_waitcnt lgkmcnt(10)
    v_mfma_f32_32x32x16_bf16 v[96:111], v[248:251], v[128:131], v[96:111]
    ds_read_b64_tr_b16 v[54:55], v42 offset:4096
    ds_read_b64_tr_b16 v[56:57], v42 offset:6144
    s_waitcnt lgkmcnt(10)
    v_mfma_f32_32x32x16_bf16 v[112:127], v[252:255], v[128:131], v[112:127]
    ds_read_b64_tr_b16 v[58:59], v43 offset:4096
    ds_read_b64_tr_b16 v[60:61], v43 offset:6144
    s_waitcnt vmcnt(19) lgkmcnt(10)
    v_mfma_f32_32x32x16_bf16 v[64:79], v[46:49], v[132:135], v[64:79]
    ds_read_b64_tr_b16 v[240:241], v24 offset:8192
    ds_read_b64_tr_b16 v[242:243], v24 offset:10240
    buffer_load_dwordx4 v[172:175], v62, s[40:43], s82 offen offset:3072
    s_waitcnt lgkmcnt(10)
    v_mfma_f32_32x32x16_bf16 v[80:95], v[50:53], v[132:135], v[80:95]
    ds_read_b64_tr_b16 v[244:245], v25 offset:8192
    ds_read_b64_tr_b16 v[246:247], v25 offset:10240
    s_add_u32 m0, s93, 7168
    s_add_u32 s59, s95, 121856
    buffer_load_dwordx4 v4, s[28:31], s59 offen lds
    s_waitcnt lgkmcnt(6)
    v_mfma_f32_32x32x16_bf16 v[96:111], v[54:57], v[132:135], v[96:111]
    ds_read_b64_tr_b16 v[248:249], v42 offset:8192
    ds_read_b64_tr_b16 v[250:251], v42 offset:10240
    s_waitcnt lgkmcnt(6)
    v_mfma_f32_32x32x16_bf16 v[112:127], v[58:61], v[132:135], v[112:127]
    ds_read_b64_tr_b16 v[252:253], v43 offset:8192
    ds_read_b64_tr_b16 v[254:255], v43 offset:10240
    s_waitcnt vmcnt(19) lgkmcnt(6)
    v_mfma_f32_32x32x16_bf16 v[64:79], v[240:243], v[136:139], v[64:79]
    ds_read_b64_tr_b16 v[46:47], v24 offset:12288
    ds_read_b64_tr_b16 v[48:49], v24 offset:14336
    s_waitcnt lgkmcnt(6)
    v_mfma_f32_32x32x16_bf16 v[80:95], v[244:247], v[136:139], v[80:95]
    ds_read_b64_tr_b16 v[50:51], v25 offset:12288
    ds_read_b64_tr_b16 v[52:53], v25 offset:14336
    s_waitcnt vmcnt(12)
    ds_read_b64_tr_b16 a[40:41], v10 offset:0
    ds_read_b64_tr_b16 a[42:43], v10 offset:1024
    ds_read_b64_tr_b16 a[44:45], v11 offset:0
    ds_read_b64_tr_b16 a[46:47], v11 offset:1024
    s_waitcnt lgkmcnt(15)
    s_add_u32 m0, s93, 8192
    s_add_u32 s59, s95, 129024
    buffer_load_dwordx4 v4, s[28:31], s59 offen lds
    s_waitcnt lgkmcnt(10)
    v_mfma_f32_32x32x16_bf16 v[96:111], v[248:251], v[136:139], v[96:111]
    ds_read_b64_tr_b16 v[54:55], v42 offset:12288
    ds_read_b64_tr_b16 v[56:57], v42 offset:14336
    s_waitcnt lgkmcnt(10)
    v_mfma_f32_32x32x16_bf16 v[112:127], v[252:255], v[136:139], v[112:127]
    ds_read_b64_tr_b16 v[58:59], v43 offset:12288
    ds_read_b64_tr_b16 v[60:61], v43 offset:14336
    s_waitcnt vmcnt(18) lgkmcnt(10)
    v_mfma_f32_32x32x16_bf16 v[64:79], v[46:49], v[140:143], v[64:79]
    ds_read_b64_tr_b16 v[240:241], v24 offset:16384
    ds_read_b64_tr_b16 v[242:243], v24 offset:18432
    s_waitcnt lgkmcnt(10)
    v_mfma_f32_32x32x16_bf16 v[80:95], v[50:53], v[140:143], v[80:95]
    ds_read_b64_tr_b16 v[244:245], v25 offset:16384
    ds_read_b64_tr_b16 v[246:247], v25 offset:18432
    s_add_u32 m0, s93, 9216
    s_add_u32 s59, s95, 136192
    buffer_load_dwordx4 v4, s[28:31], s59 offen lds
    s_waitcnt lgkmcnt(6)
    v_mfma_f32_32x32x16_bf16 v[96:111], v[54:57], v[140:143], v[96:111]
    ds_read_b64_tr_b16 v[248:249], v42 offset:16384
    ds_read_b64_tr_b16 v[250:251], v42 offset:18432
    s_waitcnt lgkmcnt(6)
    v_mfma_f32_32x32x16_bf16 v[112:127], v[58:61], v[140:143], v[112:127]
    ds_read_b64_tr_b16 v[252:253], v43 offset:16384
    ds_read_b64_tr_b16 v[254:255], v43 offset:18432
    s_waitcnt vmcnt(17) lgkmcnt(6)
    v_mfma_f32_32x32x16_bf16 v[64:79], v[240:243], v[144:147], v[64:79]
    ds_read_b64_tr_b16 v[46:47], v24 offset:20480
    ds_read_b64_tr_b16 v[48:49], v24 offset:22528
    s_waitcnt lgkmcnt(6)
    v_mfma_f32_32x32x16_bf16 v[80:95], v[244:247], v[144:147], v[80:95]
    ds_read_b64_tr_b16 v[50:51], v25 offset:20480
    ds_read_b64_tr_b16 v[52:53], v25 offset:22528
    s_waitcnt vmcnt(10)
    ds_read_b64_tr_b16 a[48:49], v10 offset:2048
    ds_read_b64_tr_b16 a[50:51], v10 offset:3072
    ds_read_b64_tr_b16 a[52:53], v11 offset:2048
    ds_read_b64_tr_b16 a[54:55], v11 offset:3072
    s_waitcnt lgkmcnt(15)
    s_add_u32 m0, s93, 0
    s_add_u32 s59, s95, 143360
    buffer_load_dwordx4 v4, s[28:31], s59 offen lds
    s_waitcnt lgkmcnt(10)
    v_mfma_f32_32x32x16_bf16 v[96:111], v[248:251], v[144:147], v[96:111]
    ds_read_b64_tr_b16 v[54:55], v42 offset:20480
    ds_read_b64_tr_b16 v[56:57], v42 offset:22528
    s_waitcnt lgkmcnt(10)
    v_mfma_f32_32x32x16_bf16 v[112:127], v[252:255], v[144:147], v[112:127]
    ds_read_b64_tr_b16 v[58:59], v43 offset:20480
    ds_read_b64_tr_b16 v[60:61], v43 offset:22528
    s_waitcnt vmcnt(16) lgkmcnt(10)
    v_mfma_f32_32x32x16_bf16 v[64:79], v[46:49], v[148:151], v[64:79]
    ds_read_b64_tr_b16 v[240:241], v24 offset:24576
    ds_read_b64_tr_b16 v[242:243], v24 offset:26624
    s_waitcnt lgkmcnt(10)
    v_mfma_f32_32x32x16_bf16 v[80:95], v[50:53], v[148:151], v[80:95]
    ds_read_b64_tr_b16 v[244:245], v25 offset:24576
    ds_read_b64_tr_b16 v[246:247], v25 offset:26624
    s_add_u32 m0, s93, 1024
    s_add_u32 s59, s95, 150528
    buffer_load_dwordx4 v4, s[28:31], s59 offen lds
    s_waitcnt lgkmcnt(6)
    v_mfma_f32_32x32x16_bf16 v[96:111], v[54:57], v[148:151], v[96:111]
    ds_read_b64_tr_b16 v[248:249], v42 offset:24576
    ds_read_b64_tr_b16 v[250:251], v42 offset:26624
    s_waitcnt lgkmcnt(6)
    v_mfma_f32_32x32x16_bf16 v[112:127], v[58:61], v[148:151], v[112:127]
    ds_read_b64_tr_b16 v[252:253], v43 offset:24576
    ds_read_b64_tr_b16 v[254:255], v43 offset:26624
    s_waitcnt vmcnt(15) lgkmcnt(6)
    v_mfma_f32_32x32x16_bf16 v[64:79], v[240:243], v[152:155], v[64:79]
    ds_read_b64_tr_b16 v[46:47], v24 offset:28672
    ds_read_b64_tr_b16 v[48:49], v24 offset:30720
    s_waitcnt lgkmcnt(6)
    v_mfma_f32_32x32x16_bf16 v[80:95], v[244:247], v[152:155], v[80:95]
    ds_read_b64_tr_b16 v[50:51], v25 offset:28672
    ds_read_b64_tr_b16 v[52:53], v25 offset:30720
    s_waitcnt vmcnt(8)
    ds_read_b64_tr_b16 a[56:57], v10 offset:4096
    ds_read_b64_tr_b16 a[58:59], v10 offset:5120
    ds_read_b64_tr_b16 a[60:61], v11 offset:4096
    ds_read_b64_tr_b16 a[62:63], v11 offset:5120
    s_waitcnt lgkmcnt(15)
    s_add_u32 m0, s93, 2048
    s_add_u32 s59, s95, 157696
    buffer_load_dwordx4 v4, s[28:31], s59 offen lds
    s_waitcnt lgkmcnt(10)
    v_mfma_f32_32x32x16_bf16 v[96:111], v[248:251], v[152:155], v[96:111]
    ds_read_b64_tr_b16 v[54:55], v42 offset:28672
    ds_read_b64_tr_b16 v[56:57], v42 offset:30720
    s_waitcnt lgkmcnt(10)
    v_mfma_f32_32x32x16_bf16 v[112:127], v[252:255], v[152:155], v[112:127]
    ds_read_b64_tr_b16 v[58:59], v43 offset:28672
    ds_read_b64_tr_b16 v[60:61], v43 offset:30720
    s_waitcnt vmcnt(14) lgkmcnt(10)
    v_mfma_f32_32x32x16_bf16 v[64:79], v[46:49], v[156:159], v[64:79]
    ds_read_b64_tr_b16 v[240:241], v24 offset:32768
    ds_read_b64_tr_b16 v[242:243], v24 offset:34816
    s_waitcnt lgkmcnt(10)
    v_mfma_f32_32x32x16_bf16 v[80:95], v[50:53], v[156:159], v[80:95]
    ds_read_b64_tr_b16 v[244:245], v25 offset:32768
    ds_read_b64_tr_b16 v[246:247], v25 offset:34816
    s_add_u32 m0, s93, 3072
    s_add_u32 s59, s95, 164864
    buffer_load_dwordx4 v4, s[28:31], s59 offen lds
    s_waitcnt lgkmcnt(6)
    v_mfma_f32_32x32x16_bf16 v[96:111], v[54:57], v[156:159], v[96:111]
    ds_read_b64_tr_b16 v[248:249], v42 offset:32768
    ds_read_b64_tr_b16 v[250:251], v42 offset:34816
    s_waitcnt lgkmcnt(6)
    v_mfma_f32_32x32x16_bf16 v[112:127], v[58:61], v[156:159], v[112:127]
    ds_read_b64_tr_b16 v[252:253], v43 offset:32768
    ds_read_b64_tr_b16 v[254:255], v43 offset:34816
    s_waitcnt vmcnt(13) lgkmcnt(6)
    v_mfma_f32_32x32x16_bf16 v[64:79], v[240:243], v[160:163], v[64:79]
    ds_read_b64_tr_b16 v[46:47], v24 offset:36864
    ds_read_b64_tr_b16 v[48:49], v24 offset:38912
    s_waitcnt lgkmcnt(6)
    v_mfma_f32_32x32x16_bf16 v[80:95], v[244:247], v[160:163], v[80:95]
    ds_read_b64_tr_b16 v[50:51], v25 offset:36864
    ds_read_b64_tr_b16 v[52:53], v25 offset:38912
    s_waitcnt vmcnt(6)
    ds_read_b64_tr_b16 a[64:65], v10 offset:6144
    ds_read_b64_tr_b16 a[66:67], v10 offset:7168
    ds_read_b64_tr_b16 a[68:69], v11 offset:6144
    ds_read_b64_tr_b16 a[70:71], v11 offset:7168
    s_waitcnt lgkmcnt(15)
    s_add_u32 m0, s93, 4096
    s_add_u32 s59, s95, 172032
    buffer_load_dwordx4 v4, s[28:31], s59 offen lds
    s_waitcnt lgkmcnt(10)
    v_mfma_f32_32x32x16_bf16 v[96:111], v[248:251], v[160:163], v[96:111]
    ds_read_b64_tr_b16 v[54:55], v42 offset:36864
    ds_read_b64_tr_b16 v[56:57], v42 offset:38912
    s_waitcnt lgkmcnt(10)
    v_mfma_f32_32x32x16_bf16 v[112:127], v[252:255], v[160:163], v[112:127]
    ds_read_b64_tr_b16 v[58:59], v43 offset:36864
    ds_read_b64_tr_b16 v[60:61], v43 offset:38912
    s_waitcnt vmcnt(12) lgkmcnt(10)
    v_mfma_f32_32x32x16_bf16 v[64:79], v[46:49], v[164:167], v[64:79]
    ds_read_b64_tr_b16 v[240:241], v24 offset:40960
    ds_read_b64_tr_b16 v[242:243], v24 offset:43008
    s_waitcnt lgkmcnt(10)
    v_mfma_f32_32x32x16_bf16 v[80:95], v[50:53], v[164:167], v[80:95]
    ds_read_b64_tr_b16 v[244:245], v25 offset:40960
    ds_read_b64_tr_b16 v[246:247], v25 offset:43008
    s_add_u32 m0, s93, 5120
    s_add_u32 s59, s95, 179200
    buffer_load_dwordx4 v4, s[28:31], s59 offen lds
    s_waitcnt lgkmcnt(6)
    v_mfma_f32_32x32x16_bf16 v[96:111], v[54:57], v[164:167], v[96:111]
    ds_read_b64_tr_b16 v[248:249], v42 offset:40960
    ds_read_b64_tr_b16 v[250:251], v42 offset:43008
    s_waitcnt lgkmcnt(6)
    v_mfma_f32_32x32x16_bf16 v[112:127], v[58:61], v[164:167], v[112:127]
    ds_read_b64_tr_b16 v[252:253], v43 offset:40960
    ds_read_b64_tr_b16 v[254:255], v43 offset:43008
    s_waitcnt vmcnt(11) lgkmcnt(6)
    v_mfma_f32_32x32x16_bf16 v[64:79], v[240:243], v[168:171], v[64:79]
    ds_read_b64_tr_b16 v[46:47], v24 offset:45056
    ds_read_b64_tr_b16 v[48:49], v24 offset:47104
    s_waitcnt lgkmcnt(6)
    v_mfma_f32_32x32x16_bf16 v[80:95], v[244:247], v[168:171], v[80:95]
    ds_read_b64_tr_b16 v[50:51], v25 offset:45056
    ds_read_b64_tr_b16 v[52:53], v25 offset:47104
    s_waitcnt vmcnt(6)
    ds_read_b64_tr_b16 a[72:73], v10 offset:8192
    ds_read_b64_tr_b16 a[74:75], v10 offset:9216
    ds_read_b64_tr_b16 a[76:77], v11 offset:8192
    ds_read_b64_tr_b16 a[78:79], v11 offset:9216
    s_waitcnt lgkmcnt(15)
    s_add_u32 m0, s93, 6144
    s_add_u32 s59, s95, 186368
    buffer_load_dwordx4 v4, s[28:31], s59 offen lds
    s_waitcnt lgkmcnt(10)
    v_mfma_f32_32x32x16_bf16 v[96:111], v[248:251], v[168:171], v[96:111]
    ds_read_b64_tr_b16 v[54:55], v42 offset:45056
    ds_read_b64_tr_b16 v[56:57], v42 offset:47104
    s_waitcnt lgkmcnt(10)
    v_mfma_f32_32x32x16_bf16 v[112:127], v[252:255], v[168:171], v[112:127]
    ds_read_b64_tr_b16 v[58:59], v43 offset:45056
    ds_read_b64_tr_b16 v[60:61], v43 offset:47104
    s_waitcnt vmcnt(10) lgkmcnt(10)
    v_mfma_f32_32x32x16_bf16 v[64:79], v[46:49], v[172:175], v[64:79]
    s_waitcnt lgkmcnt(8)
    v_mfma_f32_32x32x16_bf16 v[80:95], v[50:53], v[172:175], v[80:95]
    s_add_u32 m0, s93, 7168
    s_add_u32 s59, s95, 193536
    buffer_load_dwordx4 v4, s[28:31], s59 offen lds
    s_waitcnt lgkmcnt(2)
    v_mfma_f32_32x32x16_bf16 v[96:111], v[54:57], v[172:175], v[96:111]
    s_waitcnt lgkmcnt(0)
    v_mfma_f32_32x32x16_bf16 v[112:127], v[58:61], v[172:175], v[112:127]
    v_mfma_f32_32x32x16_bf16 v[64:79], a[224:227], v[16:19], v[64:79]
    v_mfma_f32_32x32x16_bf16 v[80:95], a[228:231], v[16:19], v[80:95]
    v_mfma_f32_32x32x16_bf16 v[96:111], a[232:235], v[16:19], v[96:111]
    v_mfma_f32_32x32x16_bf16 v[112:127], a[236:239], v[16:19], v[112:127]
    s_waitcnt lgkmcnt(0)
    s_barrier
    v_accvgpr_read_b32 v46, a153
    v_mov_b32 v47, s49
    s_nop 4
    v_pk_mul_f32 v[128:129], v[64:65], v[64:65]
    s_add_u32 m0, s92, 0
    s_add_u32 s59, s95, 200704
    buffer_load_dwordx4 v4, s[28:31], s59 offen lds
    v_pk_mul_f32 v[130:131], v[66:67], v[66:67]
    v_pk_mul_f32 v[132:133], v[68:69], v[68:69]
    v_pk_mul_f32 v[134:135], v[70:71], v[70:71]
    v_pk_mul_f32 v[136:137], v[72:73], v[72:73]
    v_pk_mul_f32 v[138:139], v[74:75], v[74:75]
    v_pk_mul_f32 v[140:141], v[76:77], v[76:77]
    v_pk_mul_f32 v[142:143], v[78:79], v[78:79]
    v_pk_fma_f32 v[128:129], v[128:129], v[22:23], v[20:21] op_sel_hi:[1,0,0]
    v_pk_fma_f32 v[130:131], v[130:131], v[22:23], v[20:21] op_sel_hi:[1,0,0]
    v_pk_fma_f32 v[132:133], v[132:133], v[22:23], v[20:21] op_sel_hi:[1,0,0]
    v_pk_fma_f32 v[134:135], v[134:135], v[22:23], v[20:21] op_sel_hi:[1,0,0]
    v_pk_fma_f32 v[136:137], v[136:137], v[22:23], v[20:21] op_sel_hi:[1,0,0]
    v_pk_fma_f32 v[138:139], v[138:139], v[22:23], v[20:21] op_sel_hi:[1,0,0]
    v_pk_fma_f32 v[140:141], v[140:141], v[22:23], v[20:21] op_sel_hi:[1,0,0]
    v_pk_fma_f32 v[142:143], v[142:143], v[22:23], v[20:21] op_sel_hi:[1,0,0]
    v_pk_mul_f32 v[128:129], v[128:129], v[64:65]
    s_add_u32 m0, s92, 1024
    s_add_u32 s59, s95, 207872
    buffer_load_dwordx4 v4, s[28:31], s59 offen lds
    v_pk_mul_f32 v[130:131], v[130:131], v[66:67]
    v_pk_mul_f32 v[132:133], v[132:133], v[68:69]
    v_pk_mul_f32 v[134:135], v[134:135], v[70:71]
    v_pk_mul_f32 v[136:137], v[136:137], v[72:73]
    v_pk_mul_f32 v[138:139], v[138:139], v[74:75]
    v_pk_mul_f32 v[140:141], v[140:141], v[76:77]
    v_pk_mul_f32 v[142:143], v[142:143], v[78:79]
    v_exp_f32 v128, v128
    v_exp_f32 v129, v129
    v_exp_f32 v130, v130
    v_exp_f32 v131, v131
    v_exp_f32 v132, v132
    s_add_u32 m0, s92, 2048
    s_add_u32 s59, s95, 215040
    buffer_load_dwordx4 v4, s[28:31], s59 offen lds
    v_exp_f32 v133, v133
    v_exp_f32 v134, v134
    v_exp_f32 v135, v135
    v_exp_f32 v136, v136
    v_exp_f32 v137, v137
    v_exp_f32 v138, v138
    v_exp_f32 v139, v139
    v_exp_f32 v140, v140
    s_add_u32 m0, s92, 3072
    s_add_u32 s59, s95, 222208
    buffer_load_dwordx4 v4, s[28:31], s59 offen lds
    v_exp_f32 v141, v141
    v_exp_f32 v142, v142
    v_exp_f32 v143, v143
    v_pk_fma_f32 v[128:129], v[128:129], v[44:45], v[44:45] op_sel_hi:[1,0,0]
    v_pk_fma_f32 v[130:131], v[130:131], v[44:45], v[44:45] op_sel_hi:[1,0,0]
    v_pk_fma_f32 v[132:133], v[132:133], v[44:45], v[44:45] op_sel_hi:[1,0,0]
    v_pk_fma_f32 v[134:135], v[134:135], v[44:45], v[44:45] op_sel_hi:[1,0,0]
    v_pk_fma_f32 v[136:137], v[136:137], v[44:45], v[44:45] op_sel_hi:[1,0,0]
    v_pk_fma_f32 v[138:139], v[138:139], v[44:45], v[44:45] op_sel_hi:[1,0,0]
    v_pk_fma_f32 v[140:141], v[140:141], v[44:45], v[44:45] op_sel_hi:[1,0,0]
    v_pk_fma_f32 v[142:143], v[142:143], v[44:45], v[44:45] op_sel_hi:[1,0,0]
    v_rcp_f32 v128, v128
    s_add_u32 m0, s92, 4096
    s_add_u32 s59, s95, 229376
    buffer_load_dwordx4 v4, s[28:31], s59 offen lds
    v_rcp_f32 v129, v129
    v_rcp_f32 v130, v130
    v_rcp_f32 v131, v131
    v_rcp_f32 v132, v132
    v_rcp_f32 v133, v133
    v_rcp_f32 v134, v134
    v_rcp_f32 v135, v135
    v_rcp_f32 v136, v136
    s_add_u32 m0, s92, 5120
    s_add_u32 s59, s95, 236544
    buffer_load_dwordx4 v4, s[28:31], s59 offen lds
    v_rcp_f32 v137, v137
    v_rcp_f32 v138, v138
    v_rcp_f32 v139, v139
    v_rcp_f32 v140, v140
    v_rcp_f32 v141, v141
    v_rcp_f32 v142, v142
    v_rcp_f32 v143, v143
    v_pk_mul_f32 v[128:129], v[128:129], v[64:65]
    v_pk_mul_f32 v[130:131], v[130:131], v[66:67]
    s_add_u32 m0, s92, 6144
    s_add_u32 s59, s95, 243712
    buffer_load_dwordx4 v4, s[28:31], s59 offen lds
    v_pk_mul_f32 v[132:133], v[132:133], v[68:69]
    v_pk_mul_f32 v[134:135], v[134:135], v[70:71]
    v_pk_mul_f32 v[136:137], v[136:137], v[72:73]
    v_pk_mul_f32 v[138:139], v[138:139], v[74:75]
    v_pk_mul_f32 v[140:141], v[140:141], v[76:77]
    v_pk_mul_f32 v[142:143], v[142:143], v[78:79]
    v_cvt_pk_bf16_f32 v160, v128, v129
    v_cvt_pk_bf16_f32 v161, v130, v131
    v_cvt_pk_bf16_f32 v162, v132, v133
    v_cvt_pk_bf16_f32 v163, v134, v135
    v_cvt_pk_bf16_f32 v164, v136, v137
    v_cvt_pk_bf16_f32 v165, v138, v139
    v_cvt_pk_bf16_f32 v166, v140, v141
    v_cvt_pk_bf16_f32 v167, v142, v143
    s_cmp_eq_u32 s50, 1
    s_cbranch_scc0 Lfb_19
    buffer_store_dwordx4 v[160:163], v62, s[40:43], s84 offen offset:0
    buffer_store_dwordx4 v[164:167], v62, s[40:43], s84 offen offset:1024
    s_branch Ldn_20
Lfb_19:
    buffer_store_dwordx4 v[160:163], v62, s[40:43], s84 offen offset:0 sc1
    buffer_store_dwordx4 v[164:167], v62, s[40:43], s84 offen offset:1024 sc1
Ldn_20:
    s_waitcnt vmcnt(15)
    ds_read_b64_tr_b16 a[80:81], v10 offset:0
    ds_read_b64_tr_b16 a[82:83], v10 offset:1024
    ds_read_b64_tr_b16 a[84:85], v11 offset:0
    ds_read_b64_tr_b16 a[86:87], v11 offset:1024
    s_waitcnt vmcnt(13)
    ds_read_b64_tr_b16 a[88:89], v10 offset:2048
    ds_read_b64_tr_b16 a[90:91], v10 offset:3072
    ds_read_b64_tr_b16 a[92:93], v11 offset:2048
    ds_read_b64_tr_b16 a[94:95], v11 offset:3072
    s_waitcnt vmcnt(11)
    ds_read_b64_tr_b16 a[96:97], v10 offset:4096
    ds_read_b64_tr_b16 a[98:99], v10 offset:5120
    ds_read_b64_tr_b16 a[100:101], v11 offset:4096
    ds_read_b64_tr_b16 a[102:103], v11 offset:5120
    s_waitcnt vmcnt(9)
    ds_read_b64_tr_b16 a[104:105], v10 offset:6144
    ds_read_b64_tr_b16 a[106:107], v10 offset:7168
    ds_read_b64_tr_b16 a[108:109], v11 offset:6144
    ds_read_b64_tr_b16 a[110:111], v11 offset:7168
    v_pk_mul_f32 v[128:129], v[80:81], v[80:81]
    s_add_u32 m0, s92, 7168
    s_add_u32 s59, s95, 250880
    buffer_load_dwordx4 v4, s[28:31], s59 offen lds
    v_pk_mul_f32 v[130:131], v[82:83], v[82:83]
    v_pk_mul_f32 v[132:133], v[84:85], v[84:85]
    v_pk_mul_f32 v[134:135], v[86:87], v[86:87]
    v_pk_mul_f32 v[136:137], v[88:89], v[88:89]
    v_pk_mul_f32 v[138:139], v[90:91], v[90:91]
    v_pk_mul_f32 v[140:141], v[92:93], v[92:93]
    v_pk_mul_f32 v[142:143], v[94:95], v[94:95]
    v_pk_fma_f32 v[128:129], v[128:129], v[22:23], v[20:21] op_sel_hi:[1,0,0]
    v_pk_fma_f32 v[130:131], v[130:131], v[22:23], v[20:21] op_sel_hi:[1,0,0]
    v_pk_fma_f32 v[132:133], v[132:133], v[22:23], v[20:21] op_sel_hi:[1,0,0]
    v_pk_fma_f32 v[134:135], v[134:135], v[22:23], v[20:21] op_sel_hi:[1,0,0]
    v_pk_fma_f32 v[136:137], v[136:137], v[22:23], v[20:21] op_sel_hi:[1,0,0]
    v_pk_fma_f32 v[138:139], v[138:139], v[22:23], v[20:21] op_sel_hi:[1,0,0]
    v_pk_fma_f32 v[140:141], v[140:141], v[22:23], v[20:21] op_sel_hi:[1,0,0]
    v_pk_fma_f32 v[142:143], v[142:143], v[22:23], v[20:21] op_sel_hi:[1,0,0]
    v_pk_mul_f32 v[128:129], v[128:129], v[80:81]
    s_add_u32 m0, s92, 8192
    s_add_u32 s59, s95, 258048
    buffer_load_dwordx4 v4, s[28:31], s59 offen lds
    v_pk_mul_f32 v[130:131], v[130:131], v[82:83]
    v_pk_mul_f32 v[132:133], v[132:133], v[84:85]
    v_pk_mul_f32 v[134:135], v[134:135], v[86:87]
    v_pk_mul_f32 v[136:137], v[136:137], v[88:89]
    v_pk_mul_f32 v[138:139], v[138:139], v[90:91]
    v_pk_mul_f32 v[140:141], v[140:141], v[92:93]
    v_pk_mul_f32 v[142:143], v[142:143], v[94:95]
    v_exp_f32 v128, v128
    v_exp_f32 v129, v129
    v_exp_f32 v130, v130
    v_exp_f32 v131, v131
    v_exp_f32 v132, v132
    s_add_u32 m0, s92, 9216
    s_add_u32 s59, s95, 265216
    buffer_load_dwordx4 v4, s[28:31], s59 offen lds
    v_exp_f32 v133, v133
    v_exp_f32 v134, v134
    v_exp_f32 v135, v135
    v_exp_f32 v136, v136
    v_exp_f32 v137, v137
    v_exp_f32 v138, v138
    v_exp_f32 v139, v139
    v_exp_f32 v140, v140
    s_add_u32 m0, s92, 10240
    s_add_u32 s59, s95, 272384
    buffer_load_dwordx4 v4, s[28:31], s59 offen lds
    v_exp_f32 v141, v141
    v_exp_f32 v142, v142
    v_exp_f32 v143, v143
    v_pk_fma_f32 v[128:129], v[128:129], v[44:45], v[44:45] op_sel_hi:[1,0,0]
    v_pk_fma_f32 v[130:131], v[130:131], v[44:45], v[44:45] op_sel_hi:[1,0,0]
    v_pk_fma_f32 v[132:133], v[132:133], v[44:45], v[44:45] op_sel_hi:[1,0,0]
    v_pk_fma_f32 v[134:135], v[134:135], v[44:45], v[44:45] op_sel_hi:[1,0,0]
    v_pk_fma_f32 v[136:137], v[136:137], v[44:45], v[44:45] op_sel_hi:[1,0,0]
    v_pk_fma_f32 v[138:139], v[138:139], v[44:45], v[44:45] op_sel_hi:[1,0,0]
    v_pk_fma_f32 v[140:141], v[140:141], v[44:45], v[44:45] op_sel_hi:[1,0,0]
    v_pk_fma_f32 v[142:143], v[142:143], v[44:45], v[44:45] op_sel_hi:[1,0,0]
    v_rcp_f32 v128, v128
    s_add_u32 m0, s92, 11264
    s_add_u32 s59, s95, 279552
    buffer_load_dwordx4 v4, s[28:31], s59 offen lds
    v_rcp_f32 v129, v129
    v_rcp_f32 v130, v130
    v_rcp_f32 v131, v131
    v_rcp_f32 v132, v132
    v_rcp_f32 v133, v133
    v_rcp_f32 v134, v134
    v_rcp_f32 v135, v135
    v_rcp_f32 v136, v136
    s_add_u32 m0, s92, 12288
    s_add_u32 s59, s95, 286720
    buffer_load_dwordx4 v4, s[28:31], s59 offen lds
    v_rcp_f32 v137, v137
    v_rcp_f32 v138, v138
    v_rcp_f32 v139, v139
    v_rcp_f32 v140, v140
    v_rcp_f32 v141, v141
    v_rcp_f32 v142, v142
    v_rcp_f32 v143, v143
    v_pk_mul_f32 v[128:129], v[128:129], v[80:81]
    v_pk_mul_f32 v[130:131], v[130:131], v[82:83]
    s_add_u32 m0, s92, 13312
    s_add_u32 s59, s95, 293888
    buffer_load_dwordx4 v4, s[28:31], s59 offen lds
    v_pk_mul_f32 v[132:133], v[132:133], v[84:85]
    v_pk_mul_f32 v[134:135], v[134:135], v[86:87]
    v_pk_mul_f32 v[136:137], v[136:137], v[88:89]
    v_pk_mul_f32 v[138:139], v[138:139], v[90:91]
    v_pk_mul_f32 v[140:141], v[140:141], v[92:93]
    v_pk_mul_f32 v[142:143], v[142:143], v[94:95]
    v_cvt_pk_bf16_f32 v168, v128, v129
    v_cvt_pk_bf16_f32 v169, v130, v131
    v_cvt_pk_bf16_f32 v170, v132, v133
    v_cvt_pk_bf16_f32 v171, v134, v135
    v_cvt_pk_bf16_f32 v172, v136, v137
    v_cvt_pk_bf16_f32 v173, v138, v139
    v_cvt_pk_bf16_f32 v174, v140, v141
    v_cvt_pk_bf16_f32 v175, v142, v143
    s_cmp_eq_u32 s50, 1
    s_cbranch_scc0 Lfb_21
    buffer_store_dwordx4 v[168:171], v62, s[40:43], s84 offen offset:2048
    buffer_store_dwordx4 v[172:175], v62, s[40:43], s84 offen offset:3072
    s_branch Ldn_22
Lfb_21:
    buffer_store_dwordx4 v[168:171], v62, s[40:43], s84 offen offset:2048 sc1
    buffer_store_dwordx4 v[172:175], v62, s[40:43], s84 offen offset:3072 sc1
Ldn_22:
    s_add_u32 s84, s84, 4096
    v_pk_mul_f32 v[128:129], v[96:97], v[96:97]
    s_add_u32 m0, s92, 14336
    s_add_u32 s59, s95, 301056
    buffer_load_dwordx4 v4, s[28:31], s59 offen lds
    v_pk_mul_f32 v[130:131], v[98:99], v[98:99]
    v_pk_mul_f32 v[132:133], v[100:101], v[100:101]
    v_pk_mul_f32 v[134:135], v[102:103], v[102:103]
    v_pk_mul_f32 v[136:137], v[104:105], v[104:105]
    v_pk_mul_f32 v[138:139], v[106:107], v[106:107]
    v_pk_mul_f32 v[140:141], v[108:109], v[108:109]
    v_pk_mul_f32 v[142:143], v[110:111], v[110:111]
    v_pk_fma_f32 v[128:129], v[128:129], v[22:23], v[20:21] op_sel_hi:[1,0,0]
    v_pk_fma_f32 v[130:131], v[130:131], v[22:23], v[20:21] op_sel_hi:[1,0,0]
    v_pk_fma_f32 v[132:133], v[132:133], v[22:23], v[20:21] op_sel_hi:[1,0,0]
    v_pk_fma_f32 v[134:135], v[134:135], v[22:23], v[20:21] op_sel_hi:[1,0,0]
    v_pk_fma_f32 v[136:137], v[136:137], v[22:23], v[20:21] op_sel_hi:[1,0,0]
    v_pk_fma_f32 v[138:139], v[138:139], v[22:23], v[20:21] op_sel_hi:[1,0,0]
    v_pk_fma_f32 v[140:141], v[140:141], v[22:23], v[20:21] op_sel_hi:[1,0,0]
    v_pk_fma_f32 v[142:143], v[142:143], v[22:23], v[20:21] op_sel_hi:[1,0,0]
    v_pk_mul_f32 v[128:129], v[128:129], v[96:97]
    s_add_u32 m0, s92, 15360
    s_add_u32 s59, s95, 308224
    buffer_load_dwordx4 v4, s[28:31], s59 offen lds
    v_pk_mul_f32 v[130:131], v[130:131], v[98:99]
    v_pk_mul_f32 v[132:133], v[132:133], v[100:101]
    v_pk_mul_f32 v[134:135], v[134:135], v[102:103]
    v_pk_mul_f32 v[136:137], v[136:137], v[104:105]
    v_pk_mul_f32 v[138:139], v[138:139], v[106:107]
    v_pk_mul_f32 v[140:141], v[140:141], v[108:109]
    v_pk_mul_f32 v[142:143], v[142:143], v[110:111]
    v_exp_f32 v128, v128
    v_exp_f32 v129, v129
    v_exp_f32 v130, v130
    v_exp_f32 v131, v131
    v_exp_f32 v132, v132
    s_add_u32 m0, s92, 16384
    s_add_u32 s59, s95, 315392
    buffer_load_dwordx4 v4, s[28:31], s59 offen lds
    v_exp_f32 v133, v133
    v_exp_f32 v134, v134
    v_exp_f32 v135, v135
    v_exp_f32 v136, v136
    v_exp_f32 v137, v137
    v_exp_f32 v138, v138
    v_exp_f32 v139, v139
    v_exp_f32 v140, v140
    s_add_u32 m0, s92, 17408
    s_add_u32 s59, s95, 322560
    buffer_load_dwordx4 v4, s[28:31], s59 offen lds
    v_exp_f32 v141, v141
    v_exp_f32 v142, v142
    v_exp_f32 v143, v143
    v_pk_fma_f32 v[128:129], v[128:129], v[44:45], v[44:45] op_sel_hi:[1,0,0]
    v_pk_fma_f32 v[130:131], v[130:131], v[44:45], v[44:45] op_sel_hi:[1,0,0]
    v_pk_fma_f32 v[132:133], v[132:133], v[44:45], v[44:45] op_sel_hi:[1,0,0]
    v_pk_fma_f32 v[134:135], v[134:135], v[44:45], v[44:45] op_sel_hi:[1,0,0]
    v_pk_fma_f32 v[136:137], v[136:137], v[44:45], v[44:45] op_sel_hi:[1,0,0]
    v_pk_fma_f32 v[138:139], v[138:139], v[44:45], v[44:45] op_sel_hi:[1,0,0]
    v_pk_fma_f32 v[140:141], v[140:141], v[44:45], v[44:45] op_sel_hi:[1,0,0]
    v_pk_fma_f32 v[142:143], v[142:143], v[44:45], v[44:45] op_sel_hi:[1,0,0]
    v_rcp_f32 v128, v128
    s_add_u32 m0, s92, 18432
    s_add_u32 s59, s95, 329728
    buffer_load_dwordx4 v4, s[28:31], s59 offen lds
    v_rcp_f32 v129, v129
    v_rcp_f32 v130, v130
    v_rcp_f32 v131, v131
    v_rcp_f32 v132, v132
    v_rcp_f32 v133, v133
    v_rcp_f32 v134, v134
    v_rcp_f32 v135, v135
    v_rcp_f32 v136, v136
    s_add_u32 m0, s92, 19456
    s_add_u32 s59, s95, 336896
    buffer_load_dwordx4 v4, s[28:31], s59 offen lds
    v_rcp_f32 v137, v137
    v_rcp_f32 v138, v138
    v_rcp_f32 v139, v139
    v_rcp_f32 v140, v140
    v_rcp_f32 v141, v141
    v_rcp_f32 v142, v142
    v_rcp_f32 v143, v143
    v_pk_mul_f32 v[128:129], v[128:129], v[96:97]
    v_pk_mul_f32 v[130:131], v[130:131], v[98:99]
    s_add_u32 m0, s92, 20480
    s_add_u32 s59, s95, 344064
    buffer_load_dwordx4 v4, s[28:31], s59 offen lds
    v_pk_mul_f32 v[132:133], v[132:133], v[100:101]
    v_pk_mul_f32 v[134:135], v[134:135], v[102:103]
    v_pk_mul_f32 v[136:137], v[136:137], v[104:105]
    v_pk_mul_f32 v[138:139], v[138:139], v[106:107]
    v_pk_mul_f32 v[140:141], v[140:141], v[108:109]
    v_pk_mul_f32 v[142:143], v[142:143], v[110:111]
    v_cvt_pk_bf16_f32 v176, v128, v129
    v_cvt_pk_bf16_f32 v177, v130, v131
    v_cvt_pk_bf16_f32 v178, v132, v133
    v_cvt_pk_bf16_f32 v179, v134, v135
    v_cvt_pk_bf16_f32 v180, v136, v137
    v_cvt_pk_bf16_f32 v181, v138, v139
    v_cvt_pk_bf16_f32 v182, v140, v141
    v_cvt_pk_bf16_f32 v183, v142, v143
    s_cmp_eq_u32 s50, 1
    s_cbranch_scc0 Lfb_23
    buffer_store_dwordx4 v[176:179], v62, s[40:43], s84 offen offset:0
    buffer_store_dwordx4 v[180:183], v62, s[40:43], s84 offen offset:1024
    s_branch Ldn_24
Lfb_23:
    buffer_store_dwordx4 v[176:179], v62, s[40:43], s84 offen offset:0 sc1
    buffer_store_dwordx4 v[180:183], v62, s[40:43], s84 offen offset:1024 sc1
Ldn_24:
    v_pk_mul_f32 v[128:129], v[112:113], v[112:113]
    s_add_u32 m0, s92, 21504
    s_add_u32 s59, s95, 351232
    buffer_load_dwordx4 v4, s[28:31], s59 offen lds
    v_pk_mul_f32 v[130:131], v[114:115], v[114:115]
    v_pk_mul_f32 v[132:133], v[116:117], v[116:117]
    v_pk_mul_f32 v[134:135], v[118:119], v[118:119]
    v_pk_mul_f32 v[136:137], v[120:121], v[120:121]
    v_pk_mul_f32 v[138:139], v[122:123], v[122:123]
    v_pk_mul_f32 v[140:141], v[124:125], v[124:125]
    v_pk_mul_f32 v[142:143], v[126:127], v[126:127]
    v_pk_fma_f32 v[128:129], v[128:129], v[22:23], v[20:21] op_sel_hi:[1,0,0]
    v_pk_fma_f32 v[130:131], v[130:131], v[22:23], v[20:21] op_sel_hi:[1,0,0]
    v_pk_fma_f32 v[132:133], v[132:133], v[22:23], v[20:21] op_sel_hi:[1,0,0]
    v_pk_fma_f32 v[134:135], v[134:135], v[22:23], v[20:21] op_sel_hi:[1,0,0]
    v_pk_fma_f32 v[136:137], v[136:137], v[22:23], v[20:21] op_sel_hi:[1,0,0]
    v_pk_fma_f32 v[138:139], v[138:139], v[22:23], v[20:21] op_sel_hi:[1,0,0]
    v_pk_fma_f32 v[140:141], v[140:141], v[22:23], v[20:21] op_sel_hi:[1,0,0]
    v_pk_fma_f32 v[142:143], v[142:143], v[22:23], v[20:21] op_sel_hi:[1,0,0]
    v_pk_mul_f32 v[128:129], v[128:129], v[112:113]
    s_add_u32 m0, s92, 22528
    s_add_u32 s59, s95, 358400
    buffer_load_dwordx4 v4, s[28:31], s59 offen lds
    v_pk_mul_f32 v[130:131], v[130:131], v[114:115]
    v_pk_mul_f32 v[132:133], v[132:133], v[116:117]
    v_pk_mul_f32 v[134:135], v[134:135], v[118:119]
    v_pk_mul_f32 v[136:137], v[136:137], v[120:121]
    v_pk_mul_f32 v[138:139], v[138:139], v[122:123]
    v_pk_mul_f32 v[140:141], v[140:141], v[124:125]
    v_pk_mul_f32 v[142:143], v[142:143], v[126:127]
    v_exp_f32 v128, v128
    v_exp_f32 v129, v129
    v_exp_f32 v130, v130
    v_exp_f32 v131, v131
    v_exp_f32 v132, v132
    s_add_u32 m0, s92, 23552
    s_add_u32 s59, s95, 365568
    buffer_load_dwordx4 v4, s[28:31], s59 offen lds
    v_exp_f32 v133, v133
    v_exp_f32 v134, v134
    v_exp_f32 v135, v135
    v_exp_f32 v136, v136
    v_exp_f32 v137, v137
    v_exp_f32 v138, v138
    v_exp_f32 v139, v139
    v_exp_f32 v140, v140
    s_add_u32 m0, s92, 24576
    s_add_u32 s59, s95, 372736
    buffer_load_dwordx4 v4, s[28:31], s59 offen lds
    v_exp_f32 v141, v141
    v_exp_f32 v142, v142
    v_exp_f32 v143, v143
    v_pk_fma_f32 v[128:129], v[128:129], v[44:45], v[44:45] op_sel_hi:[1,0,0]
    v_pk_fma_f32 v[130:131], v[130:131], v[44:45], v[44:45] op_sel_hi:[1,0,0]
    v_pk_fma_f32 v[132:133], v[132:133], v[44:45], v[44:45] op_sel_hi:[1,0,0]
    v_pk_fma_f32 v[134:135], v[134:135], v[44:45], v[44:45] op_sel_hi:[1,0,0]
    v_pk_fma_f32 v[136:137], v[136:137], v[44:45], v[44:45] op_sel_hi:[1,0,0]
    v_pk_fma_f32 v[138:139], v[138:139], v[44:45], v[44:45] op_sel_hi:[1,0,0]
    v_pk_fma_f32 v[140:141], v[140:141], v[44:45], v[44:45] op_sel_hi:[1,0,0]
    v_pk_fma_f32 v[142:143], v[142:143], v[44:45], v[44:45] op_sel_hi:[1,0,0]
    v_rcp_f32 v128, v128
    s_add_u32 m0, s92, 25600
    s_add_u32 s59, s95, 379904
    buffer_load_dwordx4 v4, s[28:31], s59 offen lds
    v_rcp_f32 v129, v129
    v_rcp_f32 v130, v130
    v_rcp_f32 v131, v131
    v_rcp_f32 v132, v132
    v_rcp_f32 v133, v133
    v_rcp_f32 v134, v134
    v_rcp_f32 v135, v135
    v_rcp_f32 v136, v136
    s_add_u32 m0, s92, 26624
    s_add_u32 s59, s95, 387072
    buffer_load_dwordx4 v4, s[28:31], s59 offen lds
    v_rcp_f32 v137, v137
    v_rcp_f32 v138, v138
    v_rcp_f32 v139, v139
    v_rcp_f32 v140, v140
    v_rcp_f32 v141, v141
    v_rcp_f32 v142, v142
    v_rcp_f32 v143, v143
    v_pk_mul_f32 v[128:129], v[128:129], v[112:113]
    v_pk_mul_f32 v[130:131], v[130:131], v[114:115]
    s_add_u32 m0, s92, 27648
    s_add_u32 s59, s95, 394240
    buffer_load_dwordx4 v4, s[28:31], s59 offen lds
    v_pk_mul_f32 v[132:133], v[132:133], v[116:117]
    v_pk_mul_f32 v[134:135], v[134:135], v[118:119]
    v_pk_mul_f32 v[136:137], v[136:137], v[120:121]
    v_pk_mul_f32 v[138:139], v[138:139], v[122:123]
    v_pk_mul_f32 v[140:141], v[140:141], v[124:125]
    v_pk_mul_f32 v[142:143], v[142:143], v[126:127]
    v_cvt_pk_bf16_f32 v184, v128, v129
    v_cvt_pk_bf16_f32 v185, v130, v131
    v_cvt_pk_bf16_f32 v186, v132, v133
    v_cvt_pk_bf16_f32 v187, v134, v135
    v_cvt_pk_bf16_f32 v188, v136, v137
    v_cvt_pk_bf16_f32 v189, v138, v139
    v_cvt_pk_bf16_f32 v190, v140, v141
    v_cvt_pk_bf16_f32 v191, v142, v143
    s_cmp_eq_u32 s50, 1
    s_cbranch_scc0 Lfb_25
    buffer_store_dwordx4 v[184:187], v62, s[40:43], s84 offen offset:2048
    buffer_store_dwordx4 v[188:191], v62, s[40:43], s84 offen offset:3072
    s_branch Ldn_26
Lfb_25:
    buffer_store_dwordx4 v[184:187], v62, s[40:43], s84 offen offset:2048 sc1
    buffer_store_dwordx4 v[188:191], v62, s[40:43], s84 offen offset:3072 sc1
Ldn_26:
    v_accvgpr_read_b32 v52, a154
    v_accvgpr_read_b32 v53, a155
    v_accvgpr_read_b32 v56, a158
    v_accvgpr_read_b32 v54, a156
    v_accvgpr_read_b32 v57, a159
    v_accvgpr_read_b32 v55, a157
    v_accvgpr_read_b32 v58, a160
    s_lshl_b32 s56, s44, 3
    s_lshl_b32 s53, s64, 1
    s_add_u32 s56, s56, s53
    s_lshr_b32 s57, s47, 1
    s_xor_b32 s82, s57, 0
    s_add_u32 s82, s82, s56
    s_mul_i32 s82, s82, 112
    s_mul_i32 s55, s47, 28
    s_add_u32 s82, s82, s55
    s_lshl_b32 s82, s82, 10
    s_add_u32 s82, s82, 8388608
    s_xor_b32 s83, s57, 1
    s_add_u32 s83, s83, s56
    s_mul_i32 s83, s83, 112
    s_mul_i32 s55, s47, 28
    s_add_u32 s83, s83, s55
    s_lshl_b32 s83, s83, 10
    s_add_u32 s83, s83, 8388608
    v_mov_b32 v48, 0x3f80
    v_cndmask_b32 v44, v48, 0, s[72:73]
    v_mov_b32 v45, 0
    s_waitcnt vmcnt(0)
    s_cmp_eq_u32 s50, 1
    s_cbranch_scc0 Lfb_27
    buffer_store_dword v47, v46, s[40:43], 0 offen
    s_branch Ldn_28
Lfb_27:
    buffer_store_dword v47, v46, s[40:43], 0 offen sc1
Ldn_28:
    v_mov_b32 v48, v44
    v_mov_b32 v49, 0
    v_mov_b32 v50, 0
    v_mov_b32 v51, 0
    s_nop 1
    v_mfma_f32_32x32x16_bf16 v[64:79], a[240:243], v[48:51], v[26:41]
    s_waitcnt lgkmcnt(0)
    s_mov_b32 s58, 0
Lpoll_29:
    buffer_load_dword v59, v52, s[40:43], 0 offen sc1
    s_waitcnt vmcnt(0)
    v_cmp_eq_u32 vcc, s49, v59
    s_nop 1
    s_cmp_eq_u64 vcc, -1
    s_cbranch_scc1 Lpd_30
    s_add_u32 s58, s58, 1
    s_cmp_lt_u32 s58, 0x40000
    s_cbranch_scc1 Lpoll_29
Lpd_30:
    buffer_load_dwordx4 v[128:131], v62, s[40:43], s82 offen offset:0
    buffer_load_dwordx4 v[132:135], v62, s[40:43], s83 offen offset:0
    buffer_load_dwordx4 v[136:139], v62, s[40:43], s82 offen offset:1024
    buffer_load_dwordx4 v[140:143], v62, s[40:43], s83 offen offset:1024
    buffer_load_dwordx4 v[144:147], v62, s[40:43], s82 offen offset:2048
    buffer_load_dwordx4 v[148:151], v62, s[40:43], s83 offen offset:2048
    buffer_load_dwordx4 v[152:155], v62, s[40:43], s82 offen offset:3072
    buffer_load_dwordx4 v[156:159], v62, s[40:43], s83 offen offset:3072
    s_add_u32 s82, s82, 4096
    buffer_load_dwordx4 v[160:163], v62, s[40:43], s82 offen offset:0
    s_add_u32 s83, s83, 4096
    buffer_load_dwordx4 v[164:167], v62, s[40:43], s83 offen offset:0
    s_waitcnt vmcnt(9)
    v_mfma_f32_32x32x16_bf16 v[64:79], a[0:3], v[128:131], v[64:79]
    buffer_load_dwordx4 v[168:171], v62, s[40:43], s82 offen offset:1024
    ds_read_b64_tr_b16 a[112:113], v8 offset:0
    v_mfma_f32_32x32x16_bf16 v[80:95], a[4:7], v[128:131], 0
    ds_read_b64_tr_b16 a[114:115], v8 offset:1024
    s_waitcnt vmcnt(9)
    v_mfma_f32_32x32x16_bf16 v[96:111], a[0:3], v[132:135], 0
    buffer_load_dwordx4 v[172:175], v62, s[40:43], s83 offen offset:1024
    ds_read_b64_tr_b16 a[116:117], v9 offset:0
    v_mfma_f32_32x32x16_bf16 v[112:127], a[4:7], v[132:135], 0
    ds_read_b64_tr_b16 a[118:119], v9 offset:1024
    s_waitcnt vmcnt(9)
    v_mfma_f32_32x32x16_bf16 v[64:79], a[8:11], v[136:139], v[64:79]
    buffer_load_dwordx4 v[176:179], v62, s[40:43], s82 offen offset:2048
    ds_read_b64_tr_b16 a[120:121], v8 offset:2048
    v_mfma_f32_32x32x16_bf16 v[80:95], a[12:15], v[136:139], v[80:95]
    ds_read_b64_tr_b16 a[122:123], v8 offset:3072
    s_waitcnt vmcnt(9)
    v_mfma_f32_32x32x16_bf16 v[96:111], a[8:11], v[140:143], v[96:111]
    buffer_load_dwordx4 v[180:183], v62, s[40:43], s83 offen offset:2048
    ds_read_b64_tr_b16 a[124:125], v9 offset:2048
    v_mfma_f32_32x32x16_bf16 v[112:127], a[12:15], v[140:143], v[112:127]
    ds_read_b64_tr_b16 a[126:127], v9 offset:3072
    s_waitcnt vmcnt(9)
    v_mfma_f32_32x32x16_bf16 v[64:79], a[16:19], v[144:147], v[64:79]
    buffer_load_dwordx4 v[184:187], v62, s[40:43], s82 offen offset:3072
    ds_read_b64_tr_b16 a[128:129], v8 offset:4096
    v_mfma_f32_32x32x16_bf16 v[80:95], a[20:23], v[144:147], v[80:95]
    ds_read_b64_tr_b16 a[130:131], v8 offset:5120
    s_waitcnt vmcnt(9)
    v_mfma_f32_32x32x16_bf16 v[96:111], a[16:19], v[148:151], v[96:111]
    buffer_load_dwordx4 v[188:191], v62, s[40:43], s83 offen offset:3072
    ds_read_b64_tr_b16 a[132:133], v9 offset:4096
    v_mfma_f32_32x32x16_bf16 v[112:127], a[20:23], v[148:151], v[112:127]
    ds_read_b64_tr_b16 a[134:135], v9 offset:5120
    s_waitcnt vmcnt(9)
    v_mfma_f32_32x32x16_bf16 v[64:79], a[24:27], v[152:155], v[64:79]
    s_add_u32 s82, s82, 4096
    buffer_load_dwordx4 v[192:195], v62, s[40:43], s82 offen offset:0
    ds_read_b64_tr_b16 a[136:137], v8 offset:6144
    v_mfma_f32_32x32x16_bf16 v[80:95], a[28:31], v[152:155], v[80:95]
    ds_read_b64_tr_b16 a[138:139], v8 offset:7168
    s_waitcnt vmcnt(9)
    v_mfma_f32_32x32x16_bf16 v[96:111], a[24:27], v[156:159], v[96:111]
    s_add_u32 s83, s83, 4096
    buffer_load_dwordx4 v[196:199], v62, s[40:43], s83 offen offset:0
    ds_read_b64_tr_b16 a[140:141], v9 offset:6144
    v_mfma_f32_32x32x16_bf16 v[112:127], a[28:31], v[156:159], v[112:127]
    ds_read_b64_tr_b16 a[142:143], v9 offset:7168
    s_waitcnt vmcnt(9)
    v_mfma_f32_32x32x16_bf16 v[64:79], a[32:35], v[160:163], v[64:79]
    buffer_load_dwordx4 v[200:203], v62, s[40:43], s82 offen offset:1024
    ds_read_b64_tr_b16 a[144:145], v8 offset:8192
    v_mfma_f32_32x32x16_bf16 v[80:95], a[36:39], v[160:163], v[80:95]
    ds_read_b64_tr_b16 a[146:147], v8 offset:9216
    s_waitcnt vmcnt(9)
    v_mfma_f32_32x32x16_bf16 v[96:111], a[32:35], v[164:167], v[96:111]
    buffer_load_dwordx4 v[204:207], v62, s[40:43], s83 offen offset:1024
    ds_read_b64_tr_b16 a[148:149], v9 offset:8192
    v_mfma_f32_32x32x16_bf16 v[112:127], a[36:39], v[164:167], v[112:127]
    ds_read_b64_tr_b16 a[150:151], v9 offset:9216
    s_waitcnt vmcnt(9)
    v_mfma_f32_32x32x16_bf16 v[64:79], a[40:43], v[168:171], v[64:79]
    buffer_load_dwordx4 v[208:211], v62, s[40:43], s82 offen offset:2048
    ds_read_b64_tr_b16 a[152:153], v8 offset:10240
    v_mfma_f32_32x32x16_bf16 v[80:95], a[44:47], v[168:171], v[80:95]
    ds_read_b64_tr_b16 a[154:155], v8 offset:11264
    s_waitcnt vmcnt(9)
    v_mfma_f32_32x32x16_bf16 v[96:111], a[40:43], v[172:175], v[96:111]
    buffer_load_dwordx4 v[212:215], v62, s[40:43], s83 offen offset:2048
    ds_read_b64_tr_b16 a[156:157], v9 offset:10240
    v_mfma_f32_32x32x16_bf16 v[112:127], a[44:47], v[172:175], v[112:127]
    ds_read_b64_tr_b16 a[158:159], v9 offset:11264
    s_waitcnt vmcnt(9)
    v_mfma_f32_32x32x16_bf16 v[64:79], a[48:51], v[176:179], v[64:79]
    buffer_load_dwordx4 v[216:219], v62, s[40:43], s82 offen offset:3072
    ds_read_b64_tr_b16 a[160:161], v8 offset:12288
    v_mfma_f32_32x32x16_bf16 v[80:95], a[52:55], v[176:179], v[80:95]
    ds_read_b64_tr_b16 a[162:163], v8 offset:13312
    s_waitcnt vmcnt(9)
    v_mfma_f32_32x32x16_bf16 v[96:111], a[48:51], v[180:183], v[96:111]
    buffer_load_dwordx4 v[220:223], v62, s[40:43], s83 offen offset:3072
    ds_read_b64_tr_b16 a[164:165], v9 offset:12288
    v_mfma_f32_32x32x16_bf16 v[112:127], a[52:55], v[180:183], v[112:127]
    ds_read_b64_tr_b16 a[166:167], v9 offset:13312
    s_waitcnt vmcnt(9)
    v_mfma_f32_32x32x16_bf16 v[64:79], a[56:59], v[184:187], v[64:79]
    s_add_u32 s82, s82, 4096
    buffer_load_dwordx4 v[224:227], v62, s[40:43], s82 offen offset:0
    ds_read_b64_tr_b16 a[168:169], v8 offset:14336
    v_mfma_f32_32x32x16_bf16 v[80:95], a[60:63], v[184:187], v[80:95]
    ds_read_b64_tr_b16 a[170:171], v8 offset:15360
    s_waitcnt vmcnt(9)
    v_mfma_f32_32x32x16_bf16 v[96:111], a[56:59], v[188:191], v[96:111]
    s_add_u32 s83, s83, 4096
    buffer_load_dwordx4 v[228:231], v62, s[40:43], s83 offen offset:0
    ds_read_b64_tr_b16 a[172:173], v9 offset:14336
    v_mfma_f32_32x32x16_bf16 v[112:127], a[60:63], v[188:191], v[112:127]
    ds_read_b64_tr_b16 a[174:175], v9 offset:15360
    s_waitcnt vmcnt(9)
    v_mfma_f32_32x32x16_bf16 v[64:79], a[64:67], v[192:195], v[64:79]
    buffer_load_dwordx4 v[232:235], v62, s[40:43], s82 offen offset:1024
    ds_read_b64_tr_b16 a[176:177], v8 offset:16384
    v_mfma_f32_32x32x16_bf16 v[80:95], a[68:71], v[192:195], v[80:95]
    ds_read_b64_tr_b16 a[178:179], v8 offset:17408
    s_waitcnt vmcnt(9)
    v_mfma_f32_32x32x16_bf16 v[96:111], a[64:67], v[196:199], v[96:111]
    buffer_load_dwordx4 v[236:239], v62, s[40:43], s83 offen offset:1024
    ds_read_b64_tr_b16 a[180:181], v9 offset:16384
    v_mfma_f32_32x32x16_bf16 v[112:127], a[68:71], v[196:199], v[112:127]
    ds_read_b64_tr_b16 a[182:183], v9 offset:17408
    s_waitcnt vmcnt(9)
    v_mfma_f32_32x32x16_bf16 v[64:79], a[72:75], v[200:203], v[64:79]
    buffer_load_dwordx4 v[240:243], v62, s[40:43], s82 offen offset:2048
    ds_read_b64_tr_b16 a[184:185], v8 offset:18432
    v_mfma_f32_32x32x16_bf16 v[80:95], a[76:79], v[200:203], v[80:95]
    ds_read_b64_tr_b16 a[186:187], v8 offset:19456
    s_waitcnt vmcnt(9)
    v_mfma_f32_32x32x16_bf16 v[96:111], a[72:75], v[204:207], v[96:111]
    buffer_load_dwordx4 v[244:247], v62, s[40:43], s83 offen offset:2048
    ds_read_b64_tr_b16 a[188:189], v9 offset:18432
    v_mfma_f32_32x32x16_bf16 v[112:127], a[76:79], v[204:207], v[112:127]
    ds_read_b64_tr_b16 a[190:191], v9 offset:19456
    s_waitcnt vmcnt(9)
    v_mfma_f32_32x32x16_bf16 v[64:79], a[80:83], v[208:211], v[64:79]
    buffer_load_dwordx4 v[248:251], v62, s[40:43], s82 offen offset:3072
    ds_read_b64_tr_b16 a[192:193], v8 offset:20480
    v_mfma_f32_32x32x16_bf16 v[80:95], a[84:87], v[208:211], v[80:95]
    ds_read_b64_tr_b16 a[194:195], v8 offset:21504
    s_waitcnt vmcnt(9)
    v_mfma_f32_32x32x16_bf16 v[96:111], a[80:83], v[212:215], v[96:111]
    buffer_load_dwordx4 v[252:255], v62, s[40:43], s83 offen offset:3072
    ds_read_b64_tr_b16 a[196:197], v9 offset:20480
    v_mfma_f32_32x32x16_bf16 v[112:127], a[84:87], v[212:215], v[112:127]
    ds_read_b64_tr_b16 a[198:199], v9 offset:21504
    s_waitcnt vmcnt(9)
    v_mfma_f32_32x32x16_bf16 v[64:79], a[88:91], v[216:219], v[64:79]
    s_add_u32 s82, s82, 4096
    buffer_load_dwordx4 v[128:131], v62, s[40:43], s82 offen offset:0
    ds_read_b64_tr_b16 a[200:201], v8 offset:22528
    v_mfma_f32_32x32x16_bf16 v[80:95], a[92:95], v[216:219], v[80:95]
    ds_read_b64_tr_b16 a[202:203], v8 offset:23552
    s_waitcnt vmcnt(9)
    v_mfma_f32_32x32x16_bf16 v[96:111], a[88:91], v[220:223], v[96:111]
    s_add_u32 s83, s83, 4096
    buffer_load_dwordx4 v[132:135], v62, s[40:43], s83 offen offset:0
    ds_read_b64_tr_b16 a[204:205], v9 offset:22528
    v_mfma_f32_32x32x16_bf16 v[112:127], a[92:95], v[220:223], v[112:127]
    ds_read_b64_tr_b16 a[206:207], v9 offset:23552
    s_waitcnt vmcnt(9)
    v_mfma_f32_32x32x16_bf16 v[64:79], a[96:99], v[224:227], v[64:79]
    buffer_load_dwordx4 v[136:139], v62, s[40:43], s82 offen offset:1024
    ds_read_b64_tr_b16 a[208:209], v8 offset:24576
    v_mfma_f32_32x32x16_bf16 v[80:95], a[100:103], v[224:227], v[80:95]
    ds_read_b64_tr_b16 a[210:211], v8 offset:25600
    s_waitcnt vmcnt(9)
    v_mfma_f32_32x32x16_bf16 v[96:111], a[96:99], v[228:231], v[96:111]
    buffer_load_dwordx4 v[140:143], v62, s[40:43], s83 offen offset:1024
    ds_read_b64_tr_b16 a[212:213], v9 offset:24576
    v_mfma_f32_32x32x16_bf16 v[112:127], a[100:103], v[228:231], v[112:127]
    ds_read_b64_tr_b16 a[214:215], v9 offset:25600
    s_waitcnt vmcnt(9)
    v_mfma_f32_32x32x16_bf16 v[64:79], a[104:107], v[232:235], v[64:79]
    buffer_load_dwordx4 v[144:147], v62, s[40:43], s82 offen offset:2048
    ds_read_b64_tr_b16 a[216:217], v8 offset:26624
    v_mfma_f32_32x32x16_bf16 v[80:95], a[108:111], v[232:235], v[80:95]
    ds_read_b64_tr_b16 a[218:219], v8 offset:27648
    s_waitcnt vmcnt(9)
    v_mfma_f32_32x32x16_bf16 v[96:111], a[104:107], v[236:239], v[96:111]
    buffer_load_dwordx4 v[148:151], v62, s[40:43], s83 offen offset:2048
    ds_read_b64_tr_b16 a[220:221], v9 offset:26624
    v_mfma_f32_32x32x16_bf16 v[112:127], a[108:111], v[236:239], v[112:127]
    ds_read_b64_tr_b16 a[222:223], v9 offset:27648
    s_waitcnt lgkmcnt(0)
    s_waitcnt vmcnt(9)
    v_mfma_f32_32x32x16_bf16 v[64:79], a[112:115], v[240:243], v[64:79]
    buffer_load_dwordx4 v[152:155], v62, s[40:43], s82 offen offset:3072
    v_mfma_f32_32x32x16_bf16 v[80:95], a[116:119], v[240:243], v[80:95]
    s_waitcnt vmcnt(9)
    v_mfma_f32_32x32x16_bf16 v[96:111], a[112:115], v[244:247], v[96:111]
    buffer_load_dwordx4 v[156:159], v62, s[40:43], s83 offen offset:3072
    v_mfma_f32_32x32x16_bf16 v[112:127], a[116:119], v[244:247], v[112:127]
    s_waitcnt vmcnt(9)
    v_mfma_f32_32x32x16_bf16 v[64:79], a[120:123], v[248:251], v[64:79]
    s_add_u32 s82, s82, 4096
    buffer_load_dwordx4 v[160:163], v62, s[40:43], s82 offen offset:0
    v_mfma_f32_32x32x16_bf16 v[80:95], a[124:127], v[248:251], v[80:95]
    s_waitcnt vmcnt(9)
    v_mfma_f32_32x32x16_bf16 v[96:111], a[120:123], v[252:255], v[96:111]
    s_add_u32 s83, s83, 4096
    buffer_load_dwordx4 v[164:167], v62, s[40:43], s83 offen offset:0
    v_mfma_f32_32x32x16_bf16 v[112:127], a[124:127], v[252:255], v[112:127]
    s_waitcnt vmcnt(9)
    v_mfma_f32_32x32x16_bf16 v[64:79], a[128:131], v[128:131], v[64:79]
    buffer_load_dwordx4 v[168:171], v62, s[40:43], s82 offen offset:1024
    v_mfma_f32_32x32x16_bf16 v[80:95], a[132:135], v[128:131], v[80:95]
    s_waitcnt vmcnt(9)
    v_mfma_f32_32x32x16_bf16 v[96:111], a[128:131], v[132:135], v[96:111]
    buffer_load_dwordx4 v[172:175], v62, s[40:43], s83 offen offset:1024
    v_mfma_f32_32x32x16_bf16 v[112:127], a[132:135], v[132:135], v[112:127]
    s_waitcnt vmcnt(9)
    v_mfma_f32_32x32x16_bf16 v[64:79], a[136:139], v[136:139], v[64:79]
    buffer_load_dwordx4 v[176:179], v62, s[40:43], s82 offen offset:2048
    v_mfma_f32_32x32x16_bf16 v[80:95], a[140:143], v[136:139], v[80:95]
    s_waitcnt vmcnt(9)
    v_mfma_f32_32x32x16_bf16 v[96:111], a[136:139], v[140:143], v[96:111]
    buffer_load_dwordx4 v[180:183], v62, s[40:43], s83 offen offset:2048
    v_mfma_f32_32x32x16_bf16 v[112:127], a[140:143], v[140:143], v[112:127]
    s_waitcnt vmcnt(9)
    v_mfma_f32_32x32x16_bf16 v[64:79], a[144:147], v[144:147], v[64:79]
    buffer_load_dwordx4 v[184:187], v62, s[40:43], s82 offen offset:3072
    v_mfma_f32_32x32x16_bf16 v[80:95], a[148:151], v[144:147], v[80:95]
    s_waitcnt vmcnt(9)
    v_mfma_f32_32x32x16_bf16 v[96:111], a[144:147], v[148:151], v[96:111]
    buffer_load_dwordx4 v[188:191], v62, s[40:43], s83 offen offset:3072
    v_mfma_f32_32x32x16_bf16 v[112:127], a[148:151], v[148:151], v[112:127]
    s_waitcnt vmcnt(9)
    v_mfma_f32_32x32x16_bf16 v[64:79], a[152:155], v[152:155], v[64:79]
    s_add_u32 s82, s82, 4096
    buffer_load_dwordx4 v[192:195], v62, s[40:43], s82 offen offset:0
    v_mfma_f32_32x32x16_bf16 v[80:95], a[156:159], v[152:155], v[80:95]
    s_waitcnt vmcnt(9)
    v_mfma_f32_32x32x16_bf16 v[96:111], a[152:155], v[156:159], v[96:111]
    s_add_u32 s83, s83, 4096
    buffer_load_dwordx4 v[196:199], v62, s[40:43], s83 offen offset:0
    v_mfma_f32_32x32x16_bf16 v[112:127], a[156:159], v[156:159], v[112:127]
    s_waitcnt vmcnt(9)
    v_mfma_f32_32x32x16_bf16 v[64:79], a[160:163], v[160:163], v[64:79]
    buffer_load_dwordx4 v[200:203], v62, s[40:43], s82 offen offset:1024
    v_mfma_f32_32x32x16_bf16 v[80:95], a[164:167], v[160:163], v[80:95]
    s_waitcnt vmcnt(9)
    v_mfma_f32_32x32x16_bf16 v[96:111], a[160:163], v[164:167], v[96:111]
    buffer_load_dwordx4 v[204:207], v62, s[40:43], s83 offen offset:1024
    v_mfma_f32_32x32x16_bf16 v[112:127], a[164:167], v[164:167], v[112:127]
    s_waitcnt vmcnt(9)
    v_mfma_f32_32x32x16_bf16 v[64:79], a[168:171], v[168:171], v[64:79]
    buffer_load_dwordx4 v[208:211], v62, s[40:43], s82 offen offset:2048
    v_mfma_f32_32x32x16_bf16 v[80:95], a[172:175], v[168:171], v[80:95]
    s_waitcnt vmcnt(9)
    v_mfma_f32_32x32x16_bf16 v[96:111], a[168:171], v[172:175], v[96:111]
    buffer_load_dwordx4 v[212:215], v62, s[40:43], s83 offen offset:2048
    v_mfma_f32_32x32x16_bf16 v[112:127], a[172:175], v[172:175], v[112:127]
    s_waitcnt vmcnt(9)
    v_mfma_f32_32x32x16_bf16 v[64:79], a[176:179], v[176:179], v[64:79]
    buffer_load_dwordx4 v[216:219], v62, s[40:43], s82 offen offset:3072
    v_mfma_f32_32x32x16_bf16 v[80:95], a[180:183], v[176:179], v[80:95]
    s_waitcnt vmcnt(9)
    v_mfma_f32_32x32x16_bf16 v[96:111], a[176:179], v[180:183], v[96:111]
    buffer_load_dwordx4 v[220:223], v62, s[40:43], s83 offen offset:3072
    v_mfma_f32_32x32x16_bf16 v[112:127], a[180:183], v[180:183], v[112:127]
    s_waitcnt vmcnt(9)
    v_mfma_f32_32x32x16_bf16 v[64:79], a[184:187], v[184:187], v[64:79]
    v_mfma_f32_32x32x16_bf16 v[80:95], a[188:191], v[184:187], v[80:95]
    s_waitcnt vmcnt(8)
    v_mfma_f32_32x32x16_bf16 v[96:111], a[184:187], v[188:191], v[96:111]
    v_mfma_f32_32x32x16_bf16 v[112:127], a[188:191], v[188:191], v[112:127]
    s_waitcnt vmcnt(0)
    v_mfma_f32_32x32x16_bf16 v[112:127], a[196:199], v[196:199], v[112:127]
    v_mfma_f32_32x32x16_bf16 v[112:127], a[204:207], v[204:207], v[112:127]
    v_mfma_f32_32x32x16_bf16 v[112:127], a[212:215], v[212:215], v[112:127]
    v_mfma_f32_32x32x16_bf16 v[112:127], a[220:223], v[220:223], v[112:127]
    v_mfma_f32_32x32x16_bf16 v[96:111], a[192:195], v[196:199], v[96:111]
    v_mfma_f32_32x32x16_bf16 v[96:111], a[200:203], v[204:207], v[96:111]
    s_nop 9
    ds_write_b128 v55, v[112:115] offset:0
    v_mfma_f32_32x32x16_bf16 v[96:111], a[208:211], v[212:215], v[96:111]
    ds_write_b128 v55, v[116:119] offset:1024
    v_mfma_f32_32x32x16_bf16 v[96:111], a[216:219], v[220:223], v[96:111]
    ds_write_b128 v55, v[120:123] offset:2048
    ds_write_b128 v55, v[124:127] offset:3072
    v_mfma_f32_32x32x16_bf16 v[80:95], a[196:199], v[192:195], v[80:95]
    v_mfma_f32_32x32x16_bf16 v[80:95], a[204:207], v[200:203], v[80:95]
    s_nop 7
    ds_write_b128 v54, v[96:99] offset:0
    v_mfma_f32_32x32x16_bf16 v[80:95], a[212:215], v[208:211], v[80:95]
    ds_write_b128 v54, v[100:103] offset:1024
    v_mfma_f32_32x32x16_bf16 v[80:95], a[220:223], v[216:219], v[80:95]
    ds_write_b128 v54, v[104:107] offset:2048
    ds_write_b128 v54, v[108:111] offset:3072
    v_mfma_f32_32x32x16_bf16 v[64:79], a[192:195], v[192:195], v[64:79]
    v_mfma_f32_32x32x16_bf16 v[64:79], a[200:203], v[200:203], v[64:79]
    s_nop 7
    ds_write_b128 v53, v[80:83] offset:0
    v_mfma_f32_32x32x16_bf16 v[64:79], a[208:211], v[208:211], v[64:79]
    ds_write_b128 v53, v[84:87] offset:1024
    v_mfma_f32_32x32x16_bf16 v[64:79], a[216:219], v[216:219], v[64:79]
    ds_write_b128 v53, v[88:91] offset:2048
    ds_write_b128 v53, v[92:95] offset:3072
    s_waitcnt lgkmcnt(0)
    s_barrier
    ds_read_b128 v[128:131], v56 offset:0
    ds_read_b128 v[132:135], v56 offset:1024
    ds_read_b128 v[136:139], v56 offset:2048
    ds_read_b128 v[140:143], v56 offset:3072
    ds_read_b128 v[144:147], v57 offset:0
    ds_read_b128 v[148:151], v57 offset:1024
    ds_read_b128 v[152:155], v57 offset:2048
    ds_read_b128 v[156:159], v57 offset:3072
    ds_read_b128 v[160:163], v58 offset:0
    ds_read_b128 v[164:167], v58 offset:1024
    ds_read_b128 v[168:171], v58 offset:2048
    ds_read_b128 v[172:175], v58 offset:3072
    s_waitcnt lgkmcnt(8)
    v_pk_add_f32 v[64:65], v[64:65], v[128:129]
    v_pk_add_f32 v[66:67], v[66:67], v[130:131]
    v_pk_add_f32 v[68:69], v[68:69], v[132:133]
    v_pk_add_f32 v[70:71], v[70:71], v[134:135]
    v_pk_add_f32 v[72:73], v[72:73], v[136:137]
    v_pk_add_f32 v[74:75], v[74:75], v[138:139]
    v_pk_add_f32 v[76:77], v[76:77], v[140:141]
    v_pk_add_f32 v[78:79], v[78:79], v[142:143]
    s_waitcnt lgkmcnt(4)
    v_pk_add_f32 v[64:65], v[64:65], v[144:145]
    v_pk_add_f32 v[66:67], v[66:67], v[146:147]
    v_pk_add_f32 v[68:69], v[68:69], v[148:149]
    v_pk_add_f32 v[70:71], v[70:71], v[150:151]
    v_pk_add_f32 v[72:73], v[72:73], v[152:153]
    v_pk_add_f32 v[74:75], v[74:75], v[154:155]
    v_pk_add_f32 v[76:77], v[76:77], v[156:157]
    v_pk_add_f32 v[78:79], v[78:79], v[158:159]
    s_waitcnt lgkmcnt(0)
    v_pk_add_f32 v[64:65], v[64:65], v[160:161]
    v_pk_add_f32 v[66:67], v[66:67], v[162:163]
    v_pk_add_f32 v[68:69], v[68:69], v[164:165]
    v_pk_add_f32 v[70:71], v[70:71], v[166:167]
    v_pk_add_f32 v[72:73], v[72:73], v[168:169]
    v_pk_add_f32 v[74:75], v[74:75], v[170:171]
    v_pk_add_f32 v[76:77], v[76:77], v[172:173]
    v_pk_add_f32 v[78:79], v[78:79], v[174:175]
    v_cvt_pk_bf16_f32 v136, v64, v65
    v_cvt_pk_bf16_f32 v137, v66, v67
    v_cvt_pk_bf16_f32 v138, v68, v69
    v_cvt_pk_bf16_f32 v139, v70, v71
    v_cvt_pk_bf16_f32 v140, v72, v73
    v_cvt_pk_bf16_f32 v141, v74, v75
    v_cvt_pk_bf16_f32 v142, v76, v77
    v_cvt_pk_bf16_f32 v143, v78, v79
    v_permlane32_swap_b32 v136, v138
    v_permlane32_swap_b32 v137, v139
    v_permlane32_swap_b32 v140, v142
    v_permlane32_swap_b32 v141, v143
    buffer_store_dwordx4 v[136:139], v6, s[36:39], s69 offen
    buffer_store_dwordx4 v[140:143], v6, s[36:39], s69 offen offset:32
    s_branch L_fin
L_nohas:
    v_add_f32 v112, v112, v116
    v_add_f32 v113, v113, v117
    v_add_f32 v114, v114, v118
    v_add_f32 v115, v115, v119
    v_add_f32 v52, v120, v124
    v_cndmask_b32 v53, v112, v113, s[76:77]
    v_cndmask_b32 v53, v53, v114, s[78:79]
    v_cndmask_b32 v53, v53, v115, s[80:81]
    v_accvgpr_read_b32 v56, a144
    v_accvgpr_read_b32 v57, a145
    v_permlane32_swap_b32 v52, v53
    v_add_f32 v52, v52, v53
    v_mov_b32 v53, v52
    s_nop 0
    s_nop 0
    v_permlane32_swap_b32 v52, v53
    v_mul_f32 v52, 0x3b124925, v52
    v_mul_f32 v53, 0x3b124925, v53
    v_sub_f32 v54, 0, v52
    v_fma_f32 v53, -v52, v52, v53
    v_cndmask_b32 v54, v54, 0, s[72:73]
    v_add_f32 v53, 0x3727c5ac, v53
    v_cvt_pk_bf16_f32 v43, v54, 0
    v_rsq_f32 v50, v53
    v_lshlrev_b32 v55, 16, v43
    v_sub_f32 v55, v54, v55
    v_cvt_pk_bf16_f32 v42, v54, v55
    ds_write_b32 v56, v50 offset:3072
    v_mul_f32 v51, 0x3fb8aa3b, v50
    v_mfma_f32_32x32x16_bf16 v[64:79], v[34:37], v[42:45], v[64:79]
    v_mfma_f32_32x32x16_bf16 v[80:95], v[42:45], v[38:41], v[80:95]
    s_add_u32 m0, s82, 0
    s_add_u32 s59, s83, 0
    buffer_load_dwordx4 v6, s[8:11], s59 offen lds
    s_waitcnt lgkmcnt(0)
    ds_read_b128 v[112:115], v57 offset:3072
    ds_read_b128 v[116:119], v57 offset:3104
    ds_read_b128 v[120:123], v57 offset:3136
    ds_read_b128 v[124:127], v57 offset:3168
    s_barrier
    s_nop 1
    v_cndmask_b32 v76, v76, 0, s[72:73]
    v_cndmask_b32 v77, v77, 0, s[72:73]
    v_cndmask_b32 v78, v78, 0, s[72:73]
    v_cndmask_b32 v79, v79, 0, s[72:73]
    v_cvt_pk_bf16_f32 v248, v64, v65
    v_cvt_pk_bf16_f32 v249, v66, v67
    v_cvt_pk_bf16_f32 v250, v68, v69
    v_cvt_pk_bf16_f32 v251, v70, v71
    v_cvt_pk_bf16_f32 v252, v72, v73
    v_cvt_pk_bf16_f32 v253, v74, v75
    v_cvt_pk_bf16_f32 v254, v76, v77
    v_cvt_pk_bf16_f32 v255, v78, v79
    v_mfma_f32_32x32x16_bf16 v[96:111], v[26:29], v[248:251], 0
    s_nop 0
    v_mfma_f32_32x32x16_bf16 v[96:111], v[30:33], v[252:255], v[96:111]
    s_waitcnt lgkmcnt(0)
    v_mul_f32 v80, v80, v112
    v_mul_f32 v81, v81, v113
    v_mul_f32 v82, v82, v114
    v_mul_f32 v83, v83, v115
    v_mul_f32 v84, v84, v116
    v_mul_f32 v85, v85, v117
    v_mul_f32 v86, v86, v118
    v_mul_f32 v87, v87, v119
    v_mul_f32 v88, v88, v120
    v_mul_f32 v89, v89, v121
    v_mul_f32 v90, v90, v122
    v_mul_f32 v91, v91, v123
    v_mul_f32 v92, v92, v124
    v_mul_f32 v93, v93, v125
    v_mul_f32 v94, v94, v126
    v_mul_f32 v95, v95, v127
    v_cmp_eq_u32 vcc, 28, v2
    v_cvt_pk_bf16_f32 v240, v80, v81
    v_cvt_pk_bf16_f32 v241, v82, v83
    v_cvt_pk_bf16_f32 v242, v84, v85
    v_cvt_pk_bf16_f32 v243, v86, v87
    v_cvt_pk_bf16_f32 v244, v88, v89
    v_cvt_pk_bf16_f32 v245, v90, v91
    v_cvt_pk_bf16_f32 v246, v92, v93
    v_cvt_pk_bf16_f32 v247, v94, v95
    v_cndmask_b32 v60, 0, v24, vcc
    v_cndmask_b32 v240, v240, v60, s[74:75]
    v_cndmask_b32 v241, v241, v60, s[74:75]
    v_cndmask_b32 v242, v242, v60, s[74:75]
    v_cndmask_b32 v243, v243, v60, s[74:75]
    v_cndmask_b32 v244, v244, v60, s[74:75]
    v_cndmask_b32 v245, v245, v60, s[74:75]
    v_cndmask_b32 v246, v246, v60, s[74:75]
    v_cndmask_b32 v247, v247, v60, s[74:75]
    v_cndmask_b32 v108, v108, v96, s[72:73]
    s_add_u32 m0, s82, 1024
    s_add_u32 s59, s83, 43008
    buffer_load_dwordx4 v6, s[8:11], s59 offen lds
    v_cndmask_b32 v109, v109, v96, s[72:73]
    v_cndmask_b32 v110, v110, v96, s[72:73]
    v_cndmask_b32 v111, v111, v96, s[72:73]
    v_max3_f32 v52, v96, v97, v98
    v_min3_f32 v53, v96, v97, v98
    v_max3_f32 v52, v52, v99, v100
    v_min3_f32 v53, v53, v99, v100
    v_max3_f32 v52, v52, v101, v102
    v_min3_f32 v53, v53, v101, v102
    v_max3_f32 v52, v52, v103, v104
    v_min3_f32 v53, v53, v103, v104
    v_max3_f32 v52, v52, v105, v106
    v_min3_f32 v53, v53, v105, v106
    v_max3_f32 v52, v52, v107, v108
    v_min3_f32 v53, v53, v107, v108
    v_max3_f32 v52, v52, v109, v110
    v_min3_f32 v53, v53, v109, v110
    v_max_f32 v52, v52, v111
    v_min_f32 v53, v53, v111
    v_sub_f32 v53, 0, v53
    s_nop 1
    v_permlane32_swap_b32 v52, v53
    v_max_f32 v52, v52, v53
    v_mov_b32 v53, v52
    s_nop 1
    v_permlane32_swap_b32 v52, v53
    v_mul_f32 v56, v51, v52
    v_mul_f32 v58, v51, v53
    v_sub_f32 v55, 0, v51
    v_cndmask_b32 v54, v51, v55, s[70:71]
    v_mov_b32 v55, v56
    v_cndmask_b32 v56, v56, v58, s[70:71]
    v_cndmask_b32 v58, v58, v55, s[70:71]
    v_pk_fma_f32 v[112:113], v[96:97], v[54:55], v[56:57] op_sel_hi:[1,0,0] neg_lo:[0,0,1] neg_hi:[0,0,1]
    v_pk_fma_f32 v[114:115], v[98:99], v[54:55], v[56:57] op_sel_hi:[1,0,0] neg_lo:[0,0,1] neg_hi:[0,0,1]
    v_pk_fma_f32 v[116:117], v[100:101], v[54:55], v[56:57] op_sel_hi:[1,0,0] neg_lo:[0,0,1] neg_hi:[0,0,1]
    v_pk_fma_f32 v[118:119], v[102:103], v[54:55], v[56:57] op_sel_hi:[1,0,0] neg_lo:[0,0,1] neg_hi:[0,0,1]
    v_pk_fma_f32 v[120:121], v[104:105], v[54:55], v[56:57] op_sel_hi:[1,0,0] neg_lo:[0,0,1] neg_hi:[0,0,1]
    v_pk_fma_f32 v[122:123], v[106:107], v[54:55], v[56:57] op_sel_hi:[1,0,0] neg_lo:[0,0,1] neg_hi:[0,0,1]
    v_pk_fma_f32 v[124:125], v[108:109], v[54:55], v[56:57] op_sel_hi:[1,0,0] neg_lo:[0,0,1] neg_hi:[0,0,1]
    v_pk_fma_f32 v[126:127], v[110:111], v[54:55], v[56:57] op_sel_hi:[1,0,0] neg_lo:[0,0,1] neg_hi:[0,0,1]
    v_pk_fma_f32 v[64:65], v[96:97], v[54:55], v[58:59] op_sel_hi:[1,0,0] neg_lo:[0,1,1] neg_hi:[0,1,1]
    v_pk_fma_f32 v[66:67], v[98:99], v[54:55], v[58:59] op_sel_hi:[1,0,0] neg_lo:[0,1,1] neg_hi:[0,1,1]
    v_pk_fma_f32 v[68:69], v[100:101], v[54:55], v[58:59] op_sel_hi:[1,0,0] neg_lo:[0,1,1] neg_hi:[0,1,1]
    v_pk_fma_f32 v[70:71], v[102:103], v[54:55], v[58:59] op_sel_hi:[1,0,0] neg_lo:[0,1,1] neg_hi:[0,1,1]
    v_pk_fma_f32 v[72:73], v[104:105], v[54:55], v[58:59] op_sel_hi:[1,0,0] neg_lo:[0,1,1] neg_hi:[0,1,1]
    v_pk_fma_f32 v[74:75], v[106:107], v[54:55], v[58:59] op_sel_hi:[1,0,0] neg_lo:[0,1,1] neg_hi:[0,1,1]
    v_pk_fma_f32 v[76:77], v[108:109], v[54:55], v[58:59] op_sel_hi:[1,0,0] neg_lo:[0,1,1] neg_hi:[0,1,1]
    v_pk_fma_f32 v[78:79], v[110:111], v[54:55], v[58:59] op_sel_hi:[1,0,0] neg_lo:[0,1,1] neg_hi:[0,1,1]
    v_exp_f32 v112, v112
    v_exp_f32 v113, v113
    v_exp_f32 v114, v114
    v_exp_f32 v115, v115
    v_exp_f32 v116, v116
    v_exp_f32 v117, v117
    v_exp_f32 v118, v118
    s_add_u32 m0, s82, 2048
    s_add_u32 s59, s83, 86016
    buffer_load_dwordx4 v6, s[8:11], s59 offen lds
    v_exp_f32 v119, v119
    v_exp_f32 v120, v120
    v_exp_f32 v121, v121
    v_exp_f32 v122, v122
    v_exp_f32 v123, v123
    v_exp_f32 v124, v124
    v_exp_f32 v125, v125
    v_exp_f32 v126, v126
    v_exp_f32 v127, v127
    v_cndmask_b32 v124, v124, 0, s[72:73]
    v_cndmask_b32 v125, v125, 0, s[72:73]
    v_cndmask_b32 v126, v126, 0, s[72:73]
    v_cndmask_b32 v127, v127, 0, s[72:73]
    v_pk_add_f32 v[96:97], v[112:113], v[114:115]
    v_pk_add_f32 v[98:99], v[116:117], v[118:119]
    v_pk_add_f32 v[100:101], v[120:121], v[122:123]
    v_pk_add_f32 v[102:103], v[124:125], v[126:127]
    v_pk_add_f32 v[96:97], v[96:97], v[98:99]
    v_pk_add_f32 v[100:101], v[100:101], v[102:103]
    v_pk_add_f32 v[96:97], v[96:97], v[100:101]
    v_add_f32 v96, v96, v97
    v_mov_b32 v97, v96
    s_nop 1
    v_permlane32_swap_b32 v96, v97
    v_add_f32 v96, v96, v97
    v_rcp_f32 v96, v96
    s_nop 0
    v_pk_mul_f32 v[112:113], v[112:113], v[96:97] op_sel_hi:[1,0]
    v_pk_mul_f32 v[114:115], v[114:115], v[96:97] op_sel_hi:[1,0]
    v_pk_mul_f32 v[116:117], v[116:117], v[96:97] op_sel_hi:[1,0]
    v_pk_mul_f32 v[118:119], v[118:119], v[96:97] op_sel_hi:[1,0]
    v_pk_mul_f32 v[120:121], v[120:121], v[96:97] op_sel_hi:[1,0]
    v_pk_mul_f32 v[122:123], v[122:123], v[96:97] op_sel_hi:[1,0]
    v_pk_mul_f32 v[124:125], v[124:125], v[96:97] op_sel_hi:[1,0]
    v_pk_mul_f32 v[126:127], v[126:127], v[96:97] op_sel_hi:[1,0]
    v_cvt_pk_bf16_f32 v80, v112, v113
    v_cvt_pk_bf16_f32 v81, v114, v115
    v_cvt_pk_bf16_f32 v82, v116, v117
    v_cvt_pk_bf16_f32 v83, v118, v119
    v_cvt_pk_bf16_f32 v84, v120, v121
    v_cvt_pk_bf16_f32 v85, v122, v123
    v_cvt_pk_bf16_f32 v86, v124, v125
    v_cvt_pk_bf16_f32 v87, v126, v127
    v_mfma_f32_32x32x16_bf16 v[96:111], v[80:83], v[16:19], 0
    s_nop 0
    v_mfma_f32_32x32x16_bf16 v[96:111], v[84:87], v[20:23], v[96:111]
    v_exp_f32 v64, v64
    s_add_u32 m0, s82, 3072
    s_add_u32 s59, s83, 129024
    buffer_load_dwordx4 v6, s[8:11], s59 offen lds
    v_exp_f32 v65, v65
    v_exp_f32 v66, v66
    v_exp_f32 v67, v67
    v_exp_f32 v68, v68
    v_exp_f32 v69, v69
    v_exp_f32 v70, v70
    v_exp_f32 v71, v71
    v_exp_f32 v72, v72
    v_exp_f32 v73, v73
    v_exp_f32 v74, v74
    v_exp_f32 v75, v75
    v_exp_f32 v76, v76
    v_exp_f32 v77, v77
    v_exp_f32 v78, v78
    v_exp_f32 v79, v79
    v_cndmask_b32 v76, v76, 0, s[72:73]
    v_cndmask_b32 v77, v77, 0, s[72:73]
    v_cndmask_b32 v78, v78, 0, s[72:73]
    v_cndmask_b32 v79, v79, 0, s[72:73]
    v_pk_add_f32 v[112:113], v[64:65], v[66:67]
    v_pk_add_f32 v[114:115], v[68:69], v[70:71]
    v_pk_add_f32 v[116:117], v[72:73], v[74:75]
    v_pk_add_f32 v[118:119], v[76:77], v[78:79]
    v_pk_add_f32 v[112:113], v[112:113], v[114:115]
    v_pk_add_f32 v[116:117], v[116:117], v[118:119]
    v_pk_add_f32 v[112:113], v[112:113], v[116:117]
    v_add_f32 v112, v112, v113
    v_mov_b32 v113, v112
    s_nop 1
    v_permlane32_swap_b32 v112, v113
    v_add_f32 v112, v112, v113
    v_rcp_f32 v112, v112
    s_nop 0
    v_pk_mul_f32 v[64:65], v[64:65], v[112:113] op_sel_hi:[1,0]
    v_pk_mul_f32 v[66:67], v[66:67], v[112:113] op_sel_hi:[1,0]
    v_pk_mul_f32 v[68:69], v[68:69], v[112:113] op_sel_hi:[1,0]
    v_pk_mul_f32 v[70:71], v[70:71], v[112:113] op_sel_hi:[1,0]
    v_pk_mul_f32 v[72:73], v[72:73], v[112:113] op_sel_hi:[1,0]
    v_pk_mul_f32 v[74:75], v[74:75], v[112:113] op_sel_hi:[1,0]
    v_pk_mul_f32 v[76:77], v[76:77], v[112:113] op_sel_hi:[1,0]
    v_pk_mul_f32 v[78:79], v[78:79], v[112:113] op_sel_hi:[1,0]
    v_cvt_pk_bf16_f32 v88, v64, v65
    v_cvt_pk_bf16_f32 v89, v66, v67
    v_cvt_pk_bf16_f32 v90, v68, v69
    v_cvt_pk_bf16_f32 v91, v70, v71
    v_cvt_pk_bf16_f32 v92, v72, v73
    s_add_u32 m0, s82, 4096
    s_add_u32 s59, s83, 172032
    buffer_load_dwordx4 v6, s[8:11], s59 offen lds
    v_cvt_pk_bf16_f32 v93, v74, v75
    v_cvt_pk_bf16_f32 v94, v76, v77
    v_cvt_pk_bf16_f32 v95, v78, v79
    v_mfma_f32_32x32x16_bf16 v[112:127], v[88:91], v[16:19], 0
    s_nop 0
    v_mfma_f32_32x32x16_bf16 v[112:127], v[92:95], v[20:23], v[112:127]
    v_cvt_pk_bf16_f32 v64, v96, v97
    v_cvt_pk_bf16_f32 v65, v98, v99
    v_cvt_pk_bf16_f32 v66, v100, v101
    v_cvt_pk_bf16_f32 v67, v102, v103
    v_cvt_pk_bf16_f32 v68, v104, v105
    v_cvt_pk_bf16_f32 v69, v106, v107
    v_cvt_pk_bf16_f32 v70, v108, v109
    v_cvt_pk_bf16_f32 v71, v110, v111
    v_mfma_f32_32x32x16_bf16 v[96:111], v[64:67], v[240:243], 0
    s_nop 0
    v_mfma_f32_32x32x16_bf16 v[96:111], v[68:71], v[244:247], v[96:111]
    v_accvgpr_read_b32 v53, a140
    v_accvgpr_read_b32 v54, a141
    v_accvgpr_read_b32 v55, a142
    v_accvgpr_read_b32 v56, a143
    v_accvgpr_read_b32 v57, a139
    v_mov_b32 v58, s49
    v_cvt_pk_bf16_f32 v72, v112, v113
    v_cvt_pk_bf16_f32 v73, v114, v115
    v_cvt_pk_bf16_f32 v74, v116, v117
    v_cvt_pk_bf16_f32 v75, v118, v119
    v_cvt_pk_bf16_f32 v76, v120, v121
    v_cvt_pk_bf16_f32 v77, v122, v123
    v_cvt_pk_bf16_f32 v78, v124, v125
    v_cvt_pk_bf16_f32 v79, v126, v127
    v_mfma_f32_32x32x16_bf16 v[112:127], v[72:75], v[240:243], 0
    s_nop 0
    v_mfma_f32_32x32x16_bf16 v[112:127], v[76:79], v[244:247], v[112:127]
    ds_write_b128 v53, v[104:107] offset:0
    ds_write_b128 v53, v[108:111] offset:1024
    s_nop 9
    ds_write_b128 v54, v[112:115] offset:0
    ds_write_b128 v54, v[116:119] offset:1024
    ds_write_b128 v55, v[120:123] offset:0
    ds_write_b128 v55, v[124:127] offset:1024
    s_waitcnt lgkmcnt(0)
    s_barrier
    ds_read_b128 v[64:67], v56 offset:0
    ds_read_b128 v[68:71], v56 offset:1024
    ds_read_b128 v[72:75], v56 offset:2048
    ds_read_b128 v[76:79], v56 offset:3072
    ds_read_b128 v[80:83], v56 offset:4096
    ds_read_b128 v[84:87], v56 offset:5120
    s_waitcnt lgkmcnt(4)
    v_pk_add_f32 v[96:97], v[96:97], v[64:65]
    v_pk_add_f32 v[98:99], v[98:99], v[66:67]
    v_pk_add_f32 v[100:101], v[100:101], v[68:69]
    v_pk_add_f32 v[102:103], v[102:103], v[70:71]
    s_waitcnt lgkmcnt(0)
    v_pk_add_f32 v[72:73], v[72:73], v[80:81]
    v_pk_add_f32 v[74:75], v[74:75], v[82:83]
    v_pk_add_f32 v[76:77], v[76:77], v[84:85]
    v_pk_add_f32 v[78:79], v[78:79], v[86:87]
    v_pk_add_f32 v[96:97], v[96:97], v[72:73]
    v_pk_add_f32 v[98:99], v[98:99], v[74:75]
    v_pk_add_f32 v[100:101], v[100:101], v[76:77]
    v_pk_add_f32 v[102:103], v[102:103], v[78:79]
    v_cvt_pk_bf16_f32 v72, v96, v97
    v_cvt_pk_bf16_f32 v73, v98, v99
    v_cvt_pk_bf16_f32 v74, v100, v101
    v_cvt_pk_bf16_f32 v75, v102, v103
    buffer_store_dwordx4 v[72:75], v62, s[40:43], s101 offen sc1
    s_add_u32 m0, s82, 5120
    s_add_u32 s59, s83, 215040
    buffer_load_dwordx4 v6, s[8:11], s59 offen lds
    s_add_u32 m0, s82, 6144
    s_add_u32 s59, s83, 258048
    buffer_load_dwordx4 v6, s[8:11], s59 offen lds
    s_waitcnt vmcnt(2)
    buffer_store_dword v58, v57, s[40:43], 0 offen sc1
    v_and_b32 v58, 15, v1
    v_lshrrev_b32 v58, 2, v58
    v_bfe_u32 v59, v1, 4, 1
    v_and_b32 v60, 3, v1
    s_lshl_b32 s54, s46, 2
    s_add_u32 s54, s54, s47
    s_lshl_b32 s54, s54, 6
    s_add_u32 s54, s54, 4096
    v_and_b32 v52, 15, v1
    v_lshlrev_b32 v52, 2, v52
    v_add_u32 v52, s54, v52
    v_accvgpr_write_b32 a146, v52
    s_lshl_b32 s53, s47, 10
    v_add_u32 v52, s53, v62
    v_accvgpr_write_b32 a163, v52
    s_lshr_b32 s53, s48, 5
    s_add_u32 s53, s53, s47
    s_lshl_b32 s53, s53, 4
    s_add_u32 s53, s53, s46
    s_lshl_b32 s54, s53, 2
    s_add_u32 s54, s54, 8192
    v_mov_b32 v52, 0x80000000
    v_writelane_b32 v52, s54, 0
    v_accvgpr_write_b32 a147, v52
    s_lshr_b32 s53, s48, 5
    s_add_u32 s53, s53, s47
    s_lshl_b32 s53, s53, 4
    s_add_u32 s53, s53, s46
    s_lshl_b32 s53, s53, 11
    s_add_u32 s84, s53, 2097152
    v_lshlrev_b32 v52, 7, v1
    v_cmp_gt_u32 vcc, 16, v1
    v_mov_b32 v53, 0x80000000
    s_nop 0
    v_cndmask_b32 v52, v53, v52, vcc
    buffer_load_dword a255, v52, s[40:43], s84 offen
    s_lshl_b32 s55, s44, 8
    s_add_u32 s55, s55, 1024
    v_lshlrev_b32 v52, 3, v2
    buffer_load_dwordx2 v[88:89], v52, s[40:43], s55 offen sc1
    v_add_u32 v12, 106496, v12
    v_add_u32 v13, 106496, v13
    v_add_u32 v14, 106496, v14
    v_add_u32 v15, 106496, v15
    v_mov_b32 v64, 0
    v_mov_b32 v65, 0
    v_mov_b32 v66, 0
    v_mov_b32 v67, 0
    v_mov_b32 v68, 0
    v_mov_b32 v69, 0
    v_mov_b32 v70, 0
    v_mov_b32 v71, 0
    v_mov_b32 v72, 0
    v_mov_b32 v73, 0
    v_mov_b32 v74, 0
    v_mov_b32 v75, 0
    v_mov_b32 v76, 0
    v_mov_b32 v77, 0
    v_mov_b32 v78, 0
    v_mov_b32 v79, 0
    v_mov_b32 v112, 0
    v_mov_b32 v113, 0
    v_mov_b32 v114, 0
    v_mov_b32 v115, 0
    v_mov_b32 v116, 0
    v_mov_b32 v117, 0
    v_mov_b32 v118, 0
    v_mov_b32 v119, 0
    v_mov_b32 v48, 0
    v_mov_b32 v49, 0
    v_accvgpr_read_b32 v55, a162
    s_waitcnt vmcnt(3)
    s_barrier
    ds_read_b64_tr_b16 v[96:97], v12 offset:0
    ds_read_b64_tr_b16 v[98:99], v12 offset:256
    ds_read_b64_tr_b16 v[100:101], v13 offset:0
    ds_read_b64_tr_b16 v[102:103], v13 offset:256
    ds_read_b64_tr_b16 v[104:105], v14 offset:0
    ds_read_b64_tr_b16 v[106:107], v14 offset:256
    s_waitcnt lgkmcnt(4)
    v_mfma_f32_32x32x16_bf16 v[64:79], v[96:99], v[128:131], v[64:79]
    v_mfma_f32_4x4x4_16b_bf16 v[112:115], v[24:25], v[96:97], v[112:115]
    v_mfma_f32_4x4x4_16b_bf16 v[116:119], v[24:25], v[98:99], v[116:119]
    ds_read_b64_tr_b16 v[96:97], v15 offset:0
    ds_read_b64_tr_b16 v[98:99], v15 offset:256
    s_waitcnt lgkmcnt(4)
    v_mfma_f32_32x32x16_bf16 v[64:79], v[100:103], v[132:135], v[64:79]
    ds_read_b64_tr_b16 v[100:101], v12 offset:4096
    ds_read_b64_tr_b16 v[102:103], v12 offset:4352
    s_waitcnt lgkmcnt(4)
    v_mfma_f32_32x32x16_bf16 v[64:79], v[104:107], v[136:139], v[64:79]
    ds_read_b64_tr_b16 v[104:105], v13 offset:4096
    ds_read_b64_tr_b16 v[106:107], v13 offset:4352
    s_waitcnt lgkmcnt(4)
    v_mfma_f32_32x32x16_bf16 v[64:79], v[96:99], v[140:143], v[64:79]
    ds_read_b64_tr_b16 v[96:97], v14 offset:4096
    ds_read_b64_tr_b16 v[98:99], v14 offset:4352
    s_waitcnt lgkmcnt(4)
    v_mfma_f32_32x32x16_bf16 v[64:79], v[100:103], v[144:147], v[64:79]
    v_mfma_f32_4x4x4_16b_bf16 v[112:115], v[24:25], v[100:101], v[112:115]
    v_mfma_f32_4x4x4_16b_bf16 v[116:119], v[24:25], v[102:103], v[116:119]
    ds_read_b64_tr_b16 v[100:101], v15 offset:4096
    ds_read_b64_tr_b16 v[102:103], v15 offset:4352
    s_waitcnt lgkmcnt(4)
    v_mfma_f32_32x32x16_bf16 v[64:79], v[104:107], v[148:151], v[64:79]
    ds_read_b64_tr_b16 v[104:105], v12 offset:8192
    ds_read_b64_tr_b16 v[106:107], v12 offset:8448
    s_waitcnt lgkmcnt(4)
    v_mfma_f32_32x32x16_bf16 v[64:79], v[96:99], v[152:155], v[64:79]
    ds_read_b64_tr_b16 v[96:97], v13 offset:8192
    ds_read_b64_tr_b16 v[98:99], v13 offset:8448
    s_waitcnt lgkmcnt(4)
    v_mfma_f32_32x32x16_bf16 v[64:79], v[100:103], v[156:159], v[64:79]
    ds_read_b64_tr_b16 v[100:101], v14 offset:8192
    ds_read_b64_tr_b16 v[102:103], v14 offset:8448
    s_waitcnt lgkmcnt(4)
    v_mfma_f32_32x32x16_bf16 v[64:79], v[104:107], v[160:163], v[64:79]
    v_mfma_f32_4x4x4_16b_bf16 v[112:115], v[24:25], v[104:105], v[112:115]
    v_mfma_f32_4x4x4_16b_bf16 v[116:119], v[24:25], v[106:107], v[116:119]
    ds_read_b64_tr_b16 v[104:105], v15 offset:8192
    ds_read_b64_tr_b16 v[106:107], v15 offset:8448
    s_waitcnt lgkmcnt(4)
    v_mfma_f32_32x32x16_bf16 v[64:79], v[96:99], v[164:167], v[64:79]
    ds_read_b64_tr_b16 v[96:97], v12 offset:12288
    ds_read_b64_tr_b16 v[98:99], v12 offset:12544
    s_waitcnt lgkmcnt(4)
    v_mfma_f32_32x32x16_bf16 v[64:79], v[100:103], v[168:171], v[64:79]
    ds_read_b64_tr_b16 v[100:101], v13 offset:12288
    ds_read_b64_tr_b16 v[102:103], v13 offset:12544
    s_waitcnt lgkmcnt(4)
    v_mfma_f32_32x32x16_bf16 v[64:79], v[104:107], v[172:175], v[64:79]
    ds_read_b64_tr_b16 v[104:105], v14 offset:12288
    ds_read_b64_tr_b16 v[106:107], v14 offset:12544
    s_waitcnt lgkmcnt(4)
    v_mfma_f32_32x32x16_bf16 v[64:79], v[96:99], v[176:179], v[64:79]
    v_mfma_f32_4x4x4_16b_bf16 v[112:115], v[24:25], v[96:97], v[112:115]
    v_mfma_f32_4x4x4_16b_bf16 v[116:119], v[24:25], v[98:99], v[116:119]
    ds_read_b64_tr_b16 v[96:97], v15 offset:12288
    ds_read_b64_tr_b16 v[98:99], v15 offset:12544
    s_waitcnt lgkmcnt(4)
    v_mfma_f32_32x32x16_bf16 v[64:79], v[100:103], v[180:183], v[64:79]
    ds_read_b64_tr_b16 v[100:101], v12 offset:16384
    ds_read_b64_tr_b16 v[102:103], v12 offset:16640
    s_waitcnt lgkmcnt(4)
    v_mfma_f32_32x32x16_bf16 v[64:79], v[104:107], v[184:187], v[64:79]
    ds_read_b64_tr_b16 v[104:105], v13 offset:16384
    ds_read_b64_tr_b16 v[106:107], v13 offset:16640
    s_waitcnt lgkmcnt(4)
    v_mfma_f32_32x32x16_bf16 v[64:79], v[96:99], v[188:191], v[64:79]
    ds_read_b64_tr_b16 v[96:97], v14 offset:16384
    ds_read_b64_tr_b16 v[98:99], v14 offset:16640
    s_waitcnt lgkmcnt(4)
    v_mfma_f32_32x32x16_bf16 v[64:79], v[100:103], v[192:195], v[64:79]
    v_mfma_f32_4x4x4_16b_bf16 v[112:115], v[24:25], v[100:101], v[112:115]
    v_mfma_f32_4x4x4_16b_bf16 v[116:119], v[24:25], v[102:103], v[116:119]
    ds_read_b64_tr_b16 v[100:101], v15 offset:16384
    ds_read_b64_tr_b16 v[102:103], v15 offset:16640
    s_waitcnt lgkmcnt(4)
    v_mfma_f32_32x32x16_bf16 v[64:79], v[104:107], v[196:199], v[64:79]
    ds_read_b64_tr_b16 v[104:105], v12 offset:20480
    ds_read_b64_tr_b16 v[106:107], v12 offset:20736
    s_waitcnt lgkmcnt(4)
    v_mfma_f32_32x32x16_bf16 v[64:79], v[96:99], v[200:203], v[64:79]
    ds_read_b64_tr_b16 v[96:97], v13 offset:20480
    ds_read_b64_tr_b16 v[98:99], v13 offset:20736
    s_waitcnt lgkmcnt(4)
    v_mfma_f32_32x32x16_bf16 v[64:79], v[100:103], v[204:207], v[64:79]
    ds_read_b64_tr_b16 v[100:101], v14 offset:20480
    ds_read_b64_tr_b16 v[102:103], v14 offset:20736
    s_waitcnt lgkmcnt(4)
    v_mfma_f32_32x32x16_bf16 v[64:79], v[104:107], v[208:211], v[64:79]
    v_mfma_f32_4x4x4_16b_bf16 v[112:115], v[24:25], v[104:105], v[112:115]
    v_mfma_f32_4x4x4_16b_bf16 v[116:119], v[24:25], v[106:107], v[116:119]
    ds_read_b64_tr_b16 v[104:105], v15 offset:20480
    ds_read_b64_tr_b16 v[106:107], v15 offset:20736
    s_waitcnt lgkmcnt(4)
    v_mfma_f32_32x32x16_bf16 v[64:79], v[96:99], v[212:215], v[64:79]
    ds_read_b64_tr_b16 v[96:97], v12 offset:24576
    ds_read_b64_tr_b16 v[98:99], v12 offset:24832
    s_waitcnt lgkmcnt(4)
    v_mfma_f32_32x32x16_bf16 v[64:79], v[100:103], v[216:219], v[64:79]
    ds_read_b64_tr_b16 v[100:101], v13 offset:24576
    ds_read_b64_tr_b16 v[102:103], v13 offset:24832
    s_waitcnt lgkmcnt(4)
    v_mfma_f32_32x32x16_bf16 v[64:79], v[104:107], v[220:223], v[64:79]
    ds_read_b64_tr_b16 v[104:105], v14 offset:24576
    ds_read_b64_tr_b16 v[106:107], v14 offset:24832
    s_waitcnt lgkmcnt(4)
    v_mfma_f32_32x32x16_bf16 v[64:79], v[96:99], v[224:227], v[64:79]
    v_mfma_f32_4x4x4_16b_bf16 v[112:115], v[24:25], v[96:97], v[112:115]
    v_mfma_f32_4x4x4_16b_bf16 v[116:119], v[24:25], v[98:99], v[116:119]
    s_nop 4
    v_add_f32 v52, v112, v116
    v_mov_b32 v53, v52
    ds_read_b64_tr_b16 v[96:97], v15 offset:24576
    ds_read_b64_tr_b16 v[98:99], v15 offset:24832
    s_waitcnt lgkmcnt(4)
    v_mfma_f32_32x32x16_bf16 v[64:79], v[100:103], v[228:231], v[64:79]
    v_permlane32_swap_b32 v52, v53
    v_add_f32 v52, v52, v53
    ds_write_b32 v55, v52 offset:2048
    s_waitcnt lgkmcnt(0)
    s_barrier
    s_waitcnt lgkmcnt(3)
    v_mfma_f32_32x32x16_bf16 v[64:79], v[104:107], v[232:235], v[64:79]
    ds_read_b128 v[56:59], v62 offset:2048
    s_waitcnt lgkmcnt(2)
    v_mfma_f32_32x32x16_bf16 v[64:79], v[96:99], v[236:239], v[64:79]
    s_waitcnt lgkmcnt(0)
    v_add_f32 v56, v56, v57
    v_add_f32 v58, v58, v59
    v_add_f32 v60, v56, v58
    v_cndmask_b32 v52, v60, 0, s[72:73]
    v_cvt_pk_bf16_f32 v46, v52, v52
    v_lshlrev_b32 v53, 16, v46
    v_sub_f32 v53, v52, v53
    v_cvt_pk_bf16_f32 v47, v53, 0
    s_nop 1
    v_mfma_f32_32x32x16_bf16 v[64:79], v[46:49], v[42:45], v[64:79]
    s_nop 11
    v_cndmask_b32 v76, v76, 0, s[72:73]
    v_cndmask_b32 v77, v77, 0, s[72:73]
    v_cndmask_b32 v78, v78, 0, s[72:73]
    v_cndmask_b32 v79, v79, 0, s[72:73]
    v_cvt_pk_bf16_f32 v80, v64, v65
    v_cvt_pk_bf16_f32 v81, v66, v67
    v_cvt_pk_bf16_f32 v82, v68, v69
    v_cvt_pk_bf16_f32 v83, v70, v71
    v_cvt_pk_bf16_f32 v84, v72, v73
    v_cvt_pk_bf16_f32 v85, v74, v75
    v_cvt_pk_bf16_f32 v86, v76, v77
    v_cvt_pk_bf16_f32 v87, v78, v79
    v_mfma_f32_32x32x16_bf16 v[96:111], v[26:29], v[80:83], 0
    s_nop 0
    v_mfma_f32_32x32x16_bf16 v[96:111], v[30:33], v[84:87], v[96:111]
    s_nop 11
    v_cndmask_b32 v108, v108, v96, s[72:73]
    v_cndmask_b32 v109, v109, v96, s[72:73]
    v_cndmask_b32 v110, v110, v96, s[72:73]
    v_cndmask_b32 v111, v111, v96, s[72:73]
    v_max3_f32 v52, v96, v97, v98
    v_min3_f32 v53, v96, v97, v98
    v_max3_f32 v52, v52, v99, v100
    v_min3_f32 v53, v53, v99, v100
    v_max3_f32 v52, v52, v101, v102
    v_min3_f32 v53, v53, v101, v102
    v_max3_f32 v52, v52, v103, v104
    v_min3_f32 v53, v53, v103, v104
    v_max3_f32 v52, v52, v105, v106
    v_min3_f32 v53, v53, v105, v106
    v_max3_f32 v52, v52, v107, v108
    v_min3_f32 v53, v53, v107, v108
    v_max3_f32 v52, v52, v109, v110
    v_min3_f32 v53, v53, v109, v110
    v_max_f32 v52, v52, v111
    v_min_f32 v53, v53, v111
    v_sub_f32 v53, 0, v53
    s_nop 1
    v_permlane32_swap_b32 v52, v53
    v_max_f32 v52, v52, v53
    v_mov_b32 v53, v52
    s_nop 1
    v_permlane32_swap_b32 v52, v53
    v_mul_f32 v56, v51, v52
    v_mul_f32 v58, v51, v53
    v_mov_b32 v54, v51
    v_pk_fma_f32 v[112:113], v[96:97], v[54:55], v[56:57] op_sel_hi:[1,0,0] neg_lo:[0,0,1] neg_hi:[0,0,1]
    v_pk_fma_f32 v[114:115], v[98:99], v[54:55], v[56:57] op_sel_hi:[1,0,0] neg_lo:[0,0,1] neg_hi:[0,0,1]
    v_pk_fma_f32 v[116:117], v[100:101], v[54:55], v[56:57] op_sel_hi:[1,0,0] neg_lo:[0,0,1] neg_hi:[0,0,1]
    v_pk_fma_f32 v[118:119], v[102:103], v[54:55], v[56:57] op_sel_hi:[1,0,0] neg_lo:[0,0,1] neg_hi:[0,0,1]
    v_pk_fma_f32 v[120:121], v[104:105], v[54:55], v[56:57] op_sel_hi:[1,0,0] neg_lo:[0,0,1] neg_hi:[0,0,1]
    v_pk_fma_f32 v[122:123], v[106:107], v[54:55], v[56:57] op_sel_hi:[1,0,0] neg_lo:[0,0,1] neg_hi:[0,0,1]
    v_pk_fma_f32 v[124:125], v[108:109], v[54:55], v[56:57] op_sel_hi:[1,0,0] neg_lo:[0,0,1] neg_hi:[0,0,1]
    v_pk_fma_f32 v[126:127], v[110:111], v[54:55], v[56:57] op_sel_hi:[1,0,0] neg_lo:[0,0,1] neg_hi:[0,0,1]
    v_pk_fma_f32 v[64:65], v[96:97], v[54:55], v[58:59] op_sel_hi:[1,0,0] neg_lo:[0,1,1] neg_hi:[0,1,1]
    v_pk_fma_f32 v[66:67], v[98:99], v[54:55], v[58:59] op_sel_hi:[1,0,0] neg_lo:[0,1,1] neg_hi:[0,1,1]
    v_pk_fma_f32 v[68:69], v[100:101], v[54:55], v[58:59] op_sel_hi:[1,0,0] neg_lo:[0,1,1] neg_hi:[0,1,1]
    v_pk_fma_f32 v[70:71], v[102:103], v[54:55], v[58:59] op_sel_hi:[1,0,0] neg_lo:[0,1,1] neg_hi:[0,1,1]
    v_pk_fma_f32 v[72:73], v[104:105], v[54:55], v[58:59] op_sel_hi:[1,0,0] neg_lo:[0,1,1] neg_hi:[0,1,1]
    v_pk_fma_f32 v[74:75], v[106:107], v[54:55], v[58:59] op_sel_hi:[1,0,0] neg_lo:[0,1,1] neg_hi:[0,1,1]
    v_pk_fma_f32 v[76:77], v[108:109], v[54:55], v[58:59] op_sel_hi:[1,0,0] neg_lo:[0,1,1] neg_hi:[0,1,1]
    v_pk_fma_f32 v[78:79], v[110:111], v[54:55], v[58:59] op_sel_hi:[1,0,0] neg_lo:[0,1,1] neg_hi:[0,1,1]
    v_exp_f32 v112, v112
    v_exp_f32 v113, v113
    v_exp_f32 v114, v114
    v_exp_f32 v115, v115
    v_exp_f32 v116, v116
    v_exp_f32 v117, v117
    v_exp_f32 v118, v118
    v_exp_f32 v119, v119
    v_exp_f32 v120, v120
    v_exp_f32 v121, v121
    v_exp_f32 v122, v122
    v_exp_f32 v123, v123
    v_exp_f32 v124, v124
    v_exp_f32 v125, v125
    v_exp_f32 v126, v126
    v_exp_f32 v127, v127
    v_cndmask_b32 v124, v124, 0, s[72:73]
    v_cndmask_b32 v125, v125, 0, s[72:73]
    v_cndmask_b32 v126, v126, 0, s[72:73]
    v_cndmask_b32 v127, v127, 0, s[72:73]
    v_pk_add_f32 v[96:97], v[112:113], v[114:115]
    v_pk_add_f32 v[98:99], v[116:117], v[118:119]
    v_pk_add_f32 v[100:101], v[120:121], v[122:123]
    v_pk_add_f32 v[102:103], v[124:125], v[126:127]
    v_pk_add_f32 v[96:97], v[96:97], v[98:99]
    v_pk_add_f32 v[100:101], v[100:101], v[102:103]
    v_pk_add_f32 v[96:97], v[96:97], v[100:101]
    v_add_f32 v96, v96, v97
    v_mov_b32 v97, v96
    s_nop 1
    v_permlane32_swap_b32 v96, v97
    v_add_f32 v96, v96, v97
    v_rcp_f32 v96, v96
    s_nop 0
    v_pk_mul_f32 v[112:113], v[112:113], v[96:97] op_sel_hi:[1,0]
    v_pk_mul_f32 v[114:115], v[114:115], v[96:97] op_sel_hi:[1,0]
    v_pk_mul_f32 v[116:117], v[116:117], v[96:97] op_sel_hi:[1,0]
    v_pk_mul_f32 v[118:119], v[118:119], v[96:97] op_sel_hi:[1,0]
    v_pk_mul_f32 v[120:121], v[120:121], v[96:97] op_sel_hi:[1,0]
    v_pk_mul_f32 v[122:123], v[122:123], v[96:97] op_sel_hi:[1,0]
    v_pk_mul_f32 v[124:125], v[124:125], v[96:97] op_sel_hi:[1,0]
    v_pk_mul_f32 v[126:127], v[126:127], v[96:97] op_sel_hi:[1,0]
    v_cvt_pk_bf16_f32 v240, v112, v113
    v_cvt_pk_bf16_f32 v241, v114, v115
    v_cvt_pk_bf16_f32 v242, v116, v117
    v_cvt_pk_bf16_f32 v243, v118, v119
    v_cvt_pk_bf16_f32 v244, v120, v121
    v_cvt_pk_bf16_f32 v245, v122, v123
    v_cvt_pk_bf16_f32 v246, v124, v125
    v_cvt_pk_bf16_f32 v247, v126, v127
    v_exp_f32 v64, v64
    v_exp_f32 v65, v65
    v_exp_f32 v66, v66
    v_exp_f32 v67, v67
    v_exp_f32 v68, v68
    v_exp_f32 v69, v69
    v_exp_f32 v70, v70
    v_exp_f32 v71, v71
    v_exp_f32 v72, v72
    v_exp_f32 v73, v73
    v_exp_f32 v74, v74
    v_exp_f32 v75, v75
    v_exp_f32 v76, v76
    v_exp_f32 v77, v77
    v_exp_f32 v78, v78
    v_exp_f32 v79, v79
    v_cndmask_b32 v76, v76, 0, s[72:73]
    v_cndmask_b32 v77, v77, 0, s[72:73]
    v_cndmask_b32 v78, v78, 0, s[72:73]
    v_cndmask_b32 v79, v79, 0, s[72:73]
    v_pk_add_f32 v[96:97], v[64:65], v[66:67]
    v_pk_add_f32 v[98:99], v[68:69], v[70:71]
    v_pk_add_f32 v[100:101], v[72:73], v[74:75]
    v_pk_add_f32 v[102:103], v[76:77], v[78:79]
    v_pk_add_f32 v[96:97], v[96:97], v[98:99]
    v_pk_add_f32 v[100:101], v[100:101], v[102:103]
    v_pk_add_f32 v[96:97], v[96:97], v[100:101]
    v_add_f32 v96, v96, v97
    v_mov_b32 v97, v96
    s_nop 1
    v_permlane32_swap_b32 v96, v97
    v_add_f32 v96, v96, v97
    v_rcp_f32 v96, v96
    s_nop 0
    v_pk_mul_f32 v[64:65], v[64:65], v[96:97] op_sel_hi:[1,0]
    v_pk_mul_f32 v[66:67], v[66:67], v[96:97] op_sel_hi:[1,0]
    v_pk_mul_f32 v[68:69], v[68:69], v[96:97] op_sel_hi:[1,0]
    v_pk_mul_f32 v[70:71], v[70:71], v[96:97] op_sel_hi:[1,0]
    v_pk_mul_f32 v[72:73], v[72:73], v[96:97] op_sel_hi:[1,0]
    v_pk_mul_f32 v[74:75], v[74:75], v[96:97] op_sel_hi:[1,0]
    v_pk_mul_f32 v[76:77], v[76:77], v[96:97] op_sel_hi:[1,0]
    v_pk_mul_f32 v[78:79], v[78:79], v[96:97] op_sel_hi:[1,0]
    v_cvt_pk_bf16_f32 v248, v64, v65
    v_cvt_pk_bf16_f32 v249, v66, v67
    v_cvt_pk_bf16_f32 v250, v68, v69
    v_cvt_pk_bf16_f32 v251, v70, v71
    v_cvt_pk_bf16_f32 v252, v72, v73
    v_cvt_pk_bf16_f32 v253, v74, v75
    v_cvt_pk_bf16_f32 v254, v76, v77
    v_cvt_pk_bf16_f32 v255, v78, v79
    s_waitcnt vmcnt(0)
    v_cmp_eq_u32 vcc, s49, v88
    s_nop 1
    s_cmp_eq_u64 vcc, -1
    s_cbranch_scc1 Lxok_31
    s_mov_b32 s58, 0
    s_lshl_b32 s55, s44, 8
    s_add_u32 s55, s55, 1024
    v_lshlrev_b32 v52, 3, v2
Lxs_32:
    buffer_load_dwordx2 v[88:89], v52, s[40:43], s55 offen sc1
    s_waitcnt vmcnt(0)
    v_cmp_eq_u32 vcc, s49, v88
    s_nop 1
    s_cmp_eq_u64 vcc, -1
    s_cbranch_scc1 Lxok_31
    s_add_u32 s58, s58, 1
    s_cmp_lt_u32 s58, 0x40000
    s_cbranch_scc1 Lxs_32
Lxok_31:
    v_readfirstlane_b32 s55, v89
    s_nop 1
    v_cmp_eq_u32 vcc, s55, v89
    s_nop 1
    s_cmp_eq_u64 vcc, -1
    s_cselect_b32 s50, 1, 0
    v_accvgpr_read_b32 v52, a146
    s_lshl_b32 s53, s46, 6
    s_add_u32 s53, s53, s47
    s_lshl_b32 s53, s53, 10
    s_add_u32 s82, s53, 1048576
    s_mov_b32 s58, 0
Lpoll_33:
    buffer_load_dword v53, v52, s[40:43], 0 offen sc1
    s_waitcnt vmcnt(0)
    v_cmp_eq_u32 vcc, s49, v53
    s_nop 1
    s_cmp_eq_u64 vcc, -1
    s_cbranch_scc1 Lpd_34
    s_add_u32 s58, s58, 1
    s_cmp_lt_u32 s58, 0x40000
    s_cbranch_scc1 Lpoll_33
Lpd_34:
    s_add_u32 s54, s82, 0
    buffer_load_dwordx4 v[64:67], v62, s[40:43], s54 offen
    s_add_u32 s54, s82, 4096
    buffer_load_dwordx4 v[68:71], v62, s[40:43], s54 offen
    s_add_u32 s54, s82, 8192
    buffer_load_dwordx4 v[72:75], v62, s[40:43], s54 offen
    s_add_u32 s54, s82, 12288
    buffer_load_dwordx4 v[76:79], v62, s[40:43], s54 offen
    s_add_u32 s54, s82, 16384
    buffer_load_dwordx4 v[80:83], v62, s[40:43], s54 offen
    s_add_u32 s54, s82, 20480
    buffer_load_dwordx4 v[84:87], v62, s[40:43], s54 offen
    s_add_u32 s54, s82, 24576
    buffer_load_dwordx4 v[88:91], v62, s[40:43], s54 offen
    s_add_u32 s54, s82, 28672
    buffer_load_dwordx4 v[92:95], v62, s[40:43], s54 offen
    s_add_u32 s54, s82, 32768
    buffer_load_dwordx4 v[96:99], v62, s[40:43], s54 offen
    s_add_u32 s54, s82, 36864
    buffer_load_dwordx4 v[100:103], v62, s[40:43], s54 offen
    s_add_u32 s54, s82, 40960
    buffer_load_dwordx4 v[104:107], v62, s[40:43], s54 offen
    s_add_u32 s54, s82, 45056
    buffer_load_dwordx4 v[108:111], v62, s[40:43], s54 offen
    s_add_u32 s54, s82, 49152
    buffer_load_dwordx4 v[112:115], v62, s[40:43], s54 offen
    s_add_u32 s54, s82, 53248
    buffer_load_dwordx4 v[116:119], v62, s[40:43], s54 offen
    s_add_u32 s54, s82, 57344
    buffer_load_dwordx4 v[120:123], v62, s[40:43], s54 offen
    s_add_u32 s54, s82, 61440
    buffer_load_dwordx4 v[124:127], v62, s[40:43], s54 offen
    v_accvgpr_read_b32 v52, a163
    v_accvgpr_read_b32 v54, a147
    v_mov_b32 v61, s49
    s_waitcnt vmcnt(15)
    v_mfma_f32_32x32x16_bf16 v[212:227], a[176:179], v[64:67], 0
    s_waitcnt vmcnt(14)
    v_mfma_f32_32x32x16_bf16 v[212:227], a[176:179], v[68:71], v[212:227]
    s_waitcnt vmcnt(13)
    v_mfma_f32_32x32x16_bf16 v[212:227], a[176:179], v[72:75], v[212:227]
    s_waitcnt vmcnt(12)
    v_mfma_f32_32x32x16_bf16 v[212:227], a[176:179], v[76:79], v[212:227]
    s_waitcnt vmcnt(11)
    v_mfma_f32_32x32x16_bf16 v[212:227], a[176:179], v[80:83], v[212:227]
    s_waitcnt vmcnt(10)
    v_mfma_f32_32x32x16_bf16 v[212:227], a[176:179], v[84:87], v[212:227]
    s_waitcnt vmcnt(9)
    v_mfma_f32_32x32x16_bf16 v[212:227], a[176:179], v[88:91], v[212:227]
    s_waitcnt vmcnt(8)
    v_mfma_f32_32x32x16_bf16 v[212:227], a[176:179], v[92:95], v[212:227]
    s_waitcnt vmcnt(7)
    v_mfma_f32_32x32x16_bf16 v[212:227], a[176:179], v[96:99], v[212:227]
    s_waitcnt vmcnt(6)
    v_mfma_f32_32x32x16_bf16 v[212:227], a[176:179], v[100:103], v[212:227]
    s_waitcnt vmcnt(5)
    v_mfma_f32_32x32x16_bf16 v[212:227], a[176:179], v[104:107], v[212:227]
    s_waitcnt vmcnt(4)
    v_mfma_f32_32x32x16_bf16 v[212:227], a[176:179], v[108:111], v[212:227]
    s_waitcnt vmcnt(3)
    v_mfma_f32_32x32x16_bf16 v[212:227], a[176:179], v[112:115], v[212:227]
    s_waitcnt vmcnt(2)
    v_mfma_f32_32x32x16_bf16 v[212:227], a[176:179], v[116:119], v[212:227]
    s_waitcnt vmcnt(1)
    v_mfma_f32_32x32x16_bf16 v[212:227], a[176:179], v[120:123], v[212:227]
    s_waitcnt vmcnt(0)
    v_mfma_f32_32x32x16_bf16 v[212:227], a[176:179], v[124:127], v[212:227]
    s_nop 11
    v_cvt_pk_bf16_f32 v64, v212, v213
    v_cvt_pk_bf16_f32 v65, v214, v215
    v_cvt_pk_bf16_f32 v66, v216, v217
    v_cvt_pk_bf16_f32 v67, v218, v219
    ds_write_b128 v52, v[64:67] offset:4096
    s_waitcnt lgkmcnt(0)
    s_barrier
    ds_read_b128 v[68:71], v62 offset:4096
    ds_read_b128 v[72:75], v62 offset:5120
    ds_read_b128 v[76:79], v62 offset:6144
    ds_read_b128 v[80:83], v62 offset:7168
    s_waitcnt lgkmcnt(3)
    v_mfma_f32_32x32x16_bf16 v[96:111], v[68:71], v[240:243], 0
    s_waitcnt lgkmcnt(2)
    v_mfma_f32_32x32x16_bf16 v[96:111], v[72:75], v[244:247], v[96:111]
    s_waitcnt lgkmcnt(1)
    v_mfma_f32_32x32x16_bf16 v[96:111], v[76:79], v[248:251], v[96:111]
    s_waitcnt lgkmcnt(0)
    v_mfma_f32_32x32x16_bf16 v[96:111], v[80:83], v[252:255], v[96:111]
    s_nop 11
    v_mov_b32 v56, v108
    v_mov_b32 v57, v108
    s_nop 1
    v_permlane32_swap_b32 v56, v57
    v_add_f32 v57, 0x358637bd, v57
    v_cndmask_b32 v108, v108, 0, s[72:73]
    v_cndmask_b32 v109, v109, 0, s[72:73]
    v_cndmask_b32 v110, v110, 0, s[72:73]
    v_cndmask_b32 v111, v111, 0, s[72:73]
    v_rcp_f32 v56, v57
    s_nop 0
    v_pk_mul_f32 v[96:97], v[96:97], v[56:57] op_sel_hi:[1,0]
    v_pk_mul_f32 v[98:99], v[98:99], v[56:57] op_sel_hi:[1,0]
    v_pk_mul_f32 v[100:101], v[100:101], v[56:57] op_sel_hi:[1,0]
    v_pk_mul_f32 v[102:103], v[102:103], v[56:57] op_sel_hi:[1,0]
    v_pk_mul_f32 v[104:105], v[104:105], v[56:57] op_sel_hi:[1,0]
    v_pk_mul_f32 v[106:107], v[106:107], v[56:57] op_sel_hi:[1,0]
    v_pk_mul_f32 v[108:109], v[108:109], v[56:57] op_sel_hi:[1,0]
    v_pk_mul_f32 v[110:111], v[110:111], v[56:57] op_sel_hi:[1,0]
    v_cvt_pk_bf16_f32 v64, v96, v97
    v_cvt_pk_bf16_f32 v65, v98, v99
    v_cvt_pk_bf16_f32 v66, v100, v101
    v_cvt_pk_bf16_f32 v67, v102, v103
    v_cvt_pk_bf16_f32 v68, v104, v105
    v_cvt_pk_bf16_f32 v69, v106, v107
    v_cvt_pk_bf16_f32 v70, v108, v109
    v_cvt_pk_bf16_f32 v71, v110, v111
    s_cmp_eq_u32 s50, 1
    s_cbranch_scc0 Lfb_35
    buffer_store_dwordx4 v[64:67], v62, s[40:43], s84 offen
    buffer_store_dwordx4 v[68:71], v62, s[40:43], s84 offen offset:1024
    s_branch Ldn_36
Lfb_35:
    buffer_store_dwordx4 v[64:67], v62, s[40:43], s84 offen sc1
    buffer_store_dwordx4 v[68:71], v62, s[40:43], s84 offen offset:1024 sc1
Ldn_36:
    s_waitcnt vmcnt(0)
    s_cmp_eq_u32 s50, 1
    s_cbranch_scc0 Lfb_37
    buffer_store_dword v61, v54, s[40:43], 0 offen
    s_branch Ldn_38
Lfb_37:
    buffer_store_dword v61, v54, s[40:43], 0 offen sc1
Ldn_38:
    s_sub_u32 s53, s45, 28
    s_lshl_b32 s53, s53, 2
    s_add_u32 s53, s53, s47
    v_lshlrev_b32 v52, 7, v1
    s_and_b32 s54, s53, 3
    s_mul_i32 s54, s54, 401408
    s_lshr_b32 s55, s53, 2
    s_lshl_b32 s55, s55, 13
    s_add_u32 s54, s54, s55
    buffer_load_dword a200, v52, s[28:31], s54 offen
    s_add_u32 s54, s54, 32768
    buffer_load_dword a201, v52, s[28:31], s54 offen
    s_add_u32 s54, s54, 32768
    buffer_load_dword a202, v52, s[28:31], s54 offen
    s_add_u32 s54, s54, 32768
    buffer_load_dword a203, v52, s[28:31], s54 offen
    s_add_u32 s54, s54, 32768
    buffer_load_dword a204, v52, s[28:31], s54 offen
    s_add_u32 s54, s54, 32768
    buffer_load_dword a205, v52, s[28:31], s54 offen
    s_add_u32 s54, s54, 32768
    buffer_load_dword a206, v52, s[28:31], s54 offen
    s_add_u32 s54, s54, 32768
    buffer_load_dword a207, v52, s[28:31], s54 offen
    s_add_u32 s54, s54, 32768
    buffer_load_dword a208, v52, s[28:31], s54 offen
    s_add_u32 s54, s54, 32768
    buffer_load_dword a209, v52, s[28:31], s54 offen
    s_add_u32 s54, s54, 32768
    buffer_load_dword a210, v52, s[28:31], s54 offen
    s_add_u32 s54, s54, 32768
    buffer_load_dword a211, v52, s[28:31], s54 offen
    s_add_u32 s54, s54, 32768
    buffer_load_dword a212, v52, s[28:31], s54 offen
    s_add_u32 s54, s54, 32768
    s_cmp_eq_u32 s50, 1
    s_cbranch_scc0 Lnoh1_39
    s_mul_i32 s54, s44, 917504
    s_lshl_b32 s55, s53, 13
    s_add_u32 s54, s54, s55
    s_add_u32 s54, s54, 8388608
    buffer_load_dword a64, v52, s[40:43], s54 offen
    s_add_u32 s54, s54, 131072
    buffer_load_dword a65, v52, s[40:43], s54 offen
    s_add_u32 s54, s54, 131072
    buffer_load_dword a66, v52, s[40:43], s54 offen
    s_add_u32 s54, s54, 131072
    buffer_load_dword a67, v52, s[40:43], s54 offen
    s_add_u32 s54, s54, 131072
    buffer_load_dword a68, v52, s[40:43], s54 offen
    s_add_u32 s54, s54, 131072
    buffer_load_dword a69, v52, s[40:43], s54 offen
    s_add_u32 s54, s54, 131072
    buffer_load_dword a70, v52, s[40:43], s54 offen
    s_add_u32 s54, s54, 131072
Lnoh1_39:
L_fin:
    s_cmp_eq_u32 s2, 0
    s_cbranch_scc0 L_noep
    s_mov_b32 s53, 0
    v_mov_b32 v52, 0x80000000
    v_writelane_b32 v52, s53, 0
    v_mov_b32 v53, s49
    s_cmp_eq_u32 s47, 0
    s_cbranch_scc0 L_noep
    buffer_store_dword v53, v52, s[40:43], 0 offen sc1
L_noep:
    s_waitcnt vmcnt(0)
L_end:
    s_endpgm

.section .rodata,"a"
.p2align 6
.amdhsa_kernel sequential_preLN__linear_kernel_hedgehog__dense_activation_gelu__prompt_kernel
  .amdhsa_next_free_vgpr 512
  .amdhsa_next_free_sgpr 102
  .amdhsa_accum_offset 256
  .amdhsa_group_segment_fixed_size 0
  .amdhsa_kernarg_size 96
  .amdhsa_user_sgpr_count 2
  .amdhsa_user_sgpr_kernarg_segment_ptr 1
  .amdhsa_system_sgpr_workgroup_id_x 1
.end_amdhsa_kernel
```
